```python
import torch

def _softmax(x, axis=-1):
    return torch.softmax(x, dim=axis)
def _gelu(x):
    return torch.nn.functional.gelu(x, approximate="tanh")
def _silu(x):
    return torch.nn.functional.silu(x)
def _sigmoid(x):
    return torch.sigmoid(x)
def _layernorm(x, axis=-1, eps=1e-5):
    m = x.mean(dim=axis, keepdim=True)
    v = x.var(dim=axis, keepdim=True, unbiased=False)
    return (x - m) / torch.sqrt(v + eps)
def _scatter_add(tgt, idx, src, axis=0):
    return tgt.clone().index_add_(axis, idx, src)
def _segment_sum(src, seg, n):
    out = torch.zeros((n,) + src.shape[1:], dtype=src.dtype)
    return out.index_add_(0, seg, src)
def _pad(x, pw):
    flat = tuple(v for pair in reversed(pw) for v in pair)
    return torch.nn.functional.pad(x, flat)

kernel_name = 'parallel_sum__ssm_conv_s4__dense_activation_relu__prompt'

def setup_inputs():

    _w = (lambda a: (lambda t: t.to(torch.bfloat16) if t.is_floating_point() else t)(torch.as_tensor(a)))
    def _A_setup():
        B, L, D, N = 1, 2048, 512, 128
        A_re = -(lambda _x: torch.exp(torch.as_tensor(_x)))((lambda *s: torch.randn(*s, dtype=torch.bfloat16) * 3.2)(D, N))
        A_im = torch.pi * (lambda *s: torch.randn(*s, dtype=torch.bfloat16) * 0.1)(D, N)
        B_re = (lambda *s: torch.randn(*s, dtype=torch.bfloat16) * 0.4)(D, N)
        B_im = (lambda *s: torch.randn(*s, dtype=torch.bfloat16) * 0.4)(D, N)
        C_re = (lambda *s: torch.randn(*s, dtype=torch.bfloat16) * 0.4)(D, N)
        C_im = (lambda *s: torch.randn(*s, dtype=torch.bfloat16) * 0.4)(D, N)
        log_dt = (lambda *s: torch.randn(*s, dtype=torch.bfloat16) * 0.1)(D) * 0.5 - 4.0
        Dskip = (lambda *s: torch.randn(*s, dtype=torch.bfloat16) * 0.2)(D)
        return {
            "u": _w((lambda *s: torch.randn(*s, dtype=torch.bfloat16) * 0.05)(B, L, D)),
            "A_re": _w(A_re),
            "A_im": _w(A_im),
            "B_re": _w(B_re),
            "B_im": _w(B_im),
            "C_re": _w(C_re),
            "C_im": _w(C_im),
            "log_dt": _w(log_dt),
            "Dskip": _w(Dskip),
        }
    _A_in = _A_setup()

    def _B_setup():
        B, S, D, Dff = 1, 2048, 512, 1376
        return {
            "x": _w((lambda *s: torch.randn(*s, dtype=torch.bfloat16) * 0.05)(B, S, D)),
            "w1": _w((lambda *s: torch.randn(*s, dtype=torch.bfloat16) * 0.05)(D, Dff)),
            "w2": _w((lambda *s: torch.randn(*s, dtype=torch.bfloat16) * 0.05)(Dff, D)),
        }
    _B_in = _B_setup()

    return {
        "A_u": _A_in["u"],
        "A_A_re": _A_in["A_re"],
        "A_A_im": _A_in["A_im"],
        "A_B_re": _A_in["B_re"],
        "A_B_im": _A_in["B_im"],
        "A_C_re": _A_in["C_re"],
        "A_C_im": _A_in["C_im"],
        "A_log_dt": _A_in["log_dt"],
        "A_Dskip": _A_in["Dskip"],
        "B_x": _B_in["x"],
        "B_w1": _B_in["w1"],
        "B_w2": _B_in["w2"],
    }

def reference(A_u, A_A_re, A_A_im, A_B_re, A_B_im, A_C_re, A_C_im, A_log_dt, A_Dskip, B_x, B_w1, B_w2):
    def _A_ref(u, A_re, A_im, B_re, B_im, C_re, C_im, log_dt, Dskip):
        Bsz, L, D = u.shape
        dt = torch.exp(log_dt)[:, None]
        A = A_re + 1j * A_im
        Bc = B_re + 1j * B_im
        Cc = C_re + 1j * C_im
        logdA = dt * A
        dB = dt * Bc
        l = (lambda x, dt: x.to(dt))(torch.arange(L), A_re.dtype)
        P = torch.exp(logdA[:, :, None] * l[None, None, :])
        K = torch.einsum("dn,dnl,dn->dl", Cc, P, dB).real
        L2 = 2 * L
        Kp = _pad(K, ((0, 0), (0, L)))
        up = (lambda x, *d: x.permute(*d))(u, 0, 2, 1)
        up = _pad(up, ((0, 0), (0, 0), (0, L)))
        Kf = (lambda x, axes=(-2,-1): torch.fft.rfft2(x.float(), dim=axes))(Kp[:, None, :], axes=(-2, -1))
        Uf = (lambda x, axes=(-2,-1): torch.fft.rfft2(x.float(), dim=axes))(up[:, :, None, :], axes=(-2, -1))
        Yf = Uf * Kf[None, :, :, :]
        y = (lambda x, s, axes=(-2,-1): torch.fft.irfft2(x, s=s, dim=axes).to(torch.bfloat16))(Yf, (1, L2), axes=(-2, -1))[:, :, 0, :L]
        y = (lambda x, *d: x.permute(*d))(y, 0, 2, 1) + u * Dskip[None, None, :]
        return y

    def _B_ref(x, w1, w2):
        h = torch.einsum("bsd,df->bsf", x, w1)
        zero = torch.zeros_like(h)
        h = torch.maximum(h, zero)
        return torch.einsum("bsf,fd->bsd", h, w2)

    x = A_u
    xn = _layernorm(x, axis=-1)
    return x + _A_ref(xn, A_A_re, A_A_im, A_B_re, A_B_im, A_C_re, A_C_im, A_log_dt, A_Dskip) + _B_ref(xn, B_w1, B_w2)
```

```asm
; @launch kernel=prep_kernel grid=(944,1,1) block=(256,1,1) lds=17408
; @launch kernel=mid_kernel grid=(512,1,1) block=(512,1,1) lds=81920
; @launch kernel=fin_kernel grid=(256,1,1) block=(512,1,1) lds=114688
.amdgcn_target "amdgcn-amd-amdhsa--gfx950"
.text
.globl prep_kernel
.globl mid_kernel
.globl fin_kernel
.p2align 8
.type prep_kernel,@function
prep_kernel:
    s_cmp_ge_u32 s2, 944
    s_cbranch_scc1 L_k1_exit
    s_cmp_ge_u32 s2, 768
    s_cbranch_scc1 L_k1_pf
    s_cmp_ge_u32 s2, 512
    s_cbranch_scc1 L_k1_ln
    s_mov_b32 s28, s2
    s_load_dwordx8 s[8:15], s[0:1], 8
    s_load_dwordx4 s[16:19], s[0:1], 40
    s_load_dwordx2 s[20:21], s[0:1], 56
    s_load_dwordx2 s[22:23], s[0:1], 112
    v_and_b32 v1, 63, v0
    v_lshrrev_b32 v2, 6, v0
    v_and_b32 v3, 15, v1
    v_lshrrev_b32 v4, 4, v1
    s_lshl_b32 s3, s28, 8
    v_lshlrev_b32 v5, 6, v2
    v_lshl_add_u32 v5, v4, 4, v5
    v_and_b32 v6, 7, v3
    v_lshl_add_u32 v5, v6, 1, v5
    v_add_u32 v5, s3, v5
    s_lshl_b32 s4, s28, 1
    v_mov_b32 v6, s4
    s_waitcnt lgkmcnt(0)
    global_load_ushort v7, v6, s[20:21]
    global_load_ushort v8, v5, s[8:9]
    global_load_ushort v9, v5, s[10:11]
    global_load_ushort v10, v5, s[12:13]
    global_load_ushort v11, v5, s[14:15]
    global_load_ushort v12, v5, s[16:17]
    global_load_ushort v13, v5, s[18:19]
    v_lshrrev_b32 v32, 3, v3
    v_and_b32 v35, 7, v3
    v_lshl_add_u32 v32, v32, 7, v35
    v_lshrrev_b32 v33, 2, v3
    v_and_b32 v35, 3, v3
    v_lshlrev_b32 v35, 1, v35
    v_lshl_add_u32 v33, v33, 7, v35
    v_add_u32 v33, 0x100, v33
    v_subrev_u32 v35, 8, v3
    v_lshrrev_b32 v35, 1, v35
    v_and_b32 v36, 1, v3
    v_lshlrev_b32 v36, 2, v36
    v_lshl_add_u32 v35, v35, 7, v36
    v_add_u32 v35, 0x200, v35
    v_cmp_gt_u32 vcc, 8, v3
    s_nop 1
    v_cndmask_b32 v33, v35, v33, vcc
    v_lshlrev_b32 v34, 7, v3
    v_add_u32 v34, 0x400, v34
    v_lshlrev_b32 v35, 3, v3
    v_cvt_f32_u32 v32, v32
    v_cvt_f32_u32 v33, v33
    v_cvt_f32_u32 v34, v34
    v_cvt_f32_u32 v35, v35
    v_lshrrev_b32 v20, 4, v0
    v_and_b32 v21, 15, v0
    v_lshrrev_b32 v60, 3, v20
    v_and_b32 v22, 7, v20
    v_lshl_add_u32 v60, v60, 7, v22
    v_lshrrev_b32 v61, 2, v20
    v_and_b32 v22, 3, v20
    v_lshlrev_b32 v22, 1, v22
    v_lshl_add_u32 v61, v61, 7, v22
    v_add_u32 v61, 0x100, v61
    v_subrev_u32 v22, 8, v20
    v_lshrrev_b32 v22, 1, v22
    v_and_b32 v23, 1, v20
    v_lshlrev_b32 v23, 2, v23
    v_lshl_add_u32 v22, v22, 7, v23
    v_add_u32 v22, 0x200, v22
    v_cmp_gt_u32 vcc, 8, v20
    s_nop 1
    v_cndmask_b32 v61, v22, v61, vcc
    s_movk_i32 s7, 16255
    s_mov_b32 s24, 0x3f7f3f7f
    v_lshl_add_u32 v60, v21, 3, v60
    v_cvt_f32_u32 v60, v60
    v_lshrrev_b32 v60, 16, v60
    v_max_u32 v60, s7, v60
    v_subrev_u32 v60, s7, v60
    v_lshlrev_b32 v60, 1, v60
    v_lshl_add_u32 v61, v21, 3, v61
    v_cvt_f32_u32 v61, v61
    v_lshrrev_b32 v61, 16, v61
    v_max_u32 v61, s7, v61
    v_subrev_u32 v61, s7, v61
    v_lshlrev_b32 v61, 1, v61
    v_lshlrev_b32 v62, 1, v0
    v_add_u32 v62, 2562, v62
    v_lshlrev_b32 v22, 3, v0
    v_sub_u32 v22, 2047, v22
    v_subrev_u32 v23, 0, v22
    v_subrev_u32 v24, 1, v22
    v_cvt_f32_u32 v23, v23
    v_cvt_f32_u32 v24, v24
    v_cvt_pk_bf16_f32 v23, v23, v24
    v_pk_sub_u16 v23, v23, s24 clamp
    v_lshlrev_b32 v24, 1, v23
    v_and_b32 v64, 0xffff, v24
    v_lshrrev_b32 v65, 15, v23
    v_subrev_u32 v23, 2, v22
    v_subrev_u32 v24, 3, v22
    v_cvt_f32_u32 v23, v23
    v_cvt_f32_u32 v24, v24
    v_cvt_pk_bf16_f32 v23, v23, v24
    v_pk_sub_u16 v23, v23, s24 clamp
    v_lshlrev_b32 v24, 1, v23
    v_and_b32 v66, 0xffff, v24
    v_lshrrev_b32 v67, 15, v23
    v_subrev_u32 v23, 4, v22
    v_subrev_u32 v24, 5, v22
    v_cvt_f32_u32 v23, v23
    v_cvt_f32_u32 v24, v24
    v_cvt_pk_bf16_f32 v23, v23, v24
    v_pk_sub_u16 v23, v23, s24 clamp
    v_lshlrev_b32 v24, 1, v23
    v_and_b32 v68, 0xffff, v24
    v_lshrrev_b32 v69, 15, v23
    v_subrev_u32 v23, 6, v22
    v_subrev_u32 v24, 7, v22
    v_cvt_f32_u32 v23, v23
    v_cvt_f32_u32 v24, v24
    v_cvt_pk_bf16_f32 v23, v23, v24
    v_pk_sub_u16 v23, v23, s24 clamp
    v_lshlrev_b32 v24, 1, v23
    v_and_b32 v70, 0xffff, v24
    v_lshrrev_b32 v71, 15, v23
    v_mov_b32 v36, 0
    v_mov_b32 v37, 0
    v_mov_b32 v38, 0
    v_mov_b32 v39, 0
    v_mov_b32 v40, 0
    v_mov_b32 v41, 0
    v_mov_b32 v42, 0
    v_mov_b32 v43, 0
    v_mov_b32 v44, 0
    v_mov_b32 v45, 0
    v_mov_b32 v46, 0
    v_mov_b32 v47, 0
    s_mov_b32 s5, 0x3fb8aa3b
    s_mov_b32 s6, 0x3e22f983
    s_waitcnt vmcnt(6)
    v_lshlrev_b32 v7, 16, v7
    v_mul_f32 v7, s5, v7
    v_exp_f32 v7, v7
    s_nop 0
    v_cvt_pk_bf16_f32 v7, v7, v7
    v_lshlrev_b32 v7, 16, v7
    s_waitcnt vmcnt(0)
    v_lshlrev_b32 v8, 16, v8
    v_lshlrev_b32 v9, 16, v9
    v_lshlrev_b32 v10, 16, v10
    v_lshlrev_b32 v11, 16, v11
    v_lshlrev_b32 v12, 16, v12
    v_lshlrev_b32 v13, 16, v13
    v_mul_f32 v8, v7, v8
    v_mul_f32 v9, v7, v9
    v_mul_f32 v48, s5, v8
    v_mul_f32 v49, s6, v9
    v_mul_f32 v50, v12, v10
    v_mul_f32 v51, v12, v11
    v_fma_f32 v50, -v13, v11, v50
    v_fma_f32 v51, v13, v10, v51
    v_xor_b32 v52, 0x80000000, v51
    s_mov_b32 s25, 0x07060302
    s_mov_b32 s26, 0xffff0000
    v_mov_b32_dpp v98, v48 row_newbcast:0 row_mask:0xf bank_mask:0xf
    v_mov_b32_dpp v99, v49 row_newbcast:0 row_mask:0xf bank_mask:0xf
    v_pk_mul_f32 v[80:81], v[98:99], v[34:35] op_sel:[0,1] op_sel_hi:[1,1]
    v_pk_mul_f32 v[84:85], v[98:99], v[32:33] op_sel:[0,0] op_sel_hi:[1,0]
    v_pk_mul_f32 v[88:89], v[98:99], v[32:33] op_sel:[0,1] op_sel_hi:[1,1]
    v_pk_mul_f32 v[92:93], v[98:99], v[34:35] op_sel:[0,0] op_sel_hi:[1,0]
    v_fract_f32 v81, v81
    v_exp_f32 v80, v80
    v_fract_f32 v85, v85
    v_exp_f32 v84, v84
    v_fract_f32 v89, v89
    v_exp_f32 v88, v88
    v_fract_f32 v93, v93
    v_exp_f32 v92, v92
    v_cos_f32 v82, v81
    v_sin_f32 v83, v81
    v_cos_f32 v86, v85
    v_sin_f32 v87, v85
    v_cos_f32 v90, v89
    v_sin_f32 v91, v89
    v_cos_f32 v94, v93
    v_sin_f32 v95, v93
    v_pk_mul_f32 v[82:83], v[82:83], v[80:81] op_sel:[0,0] op_sel_hi:[1,0]
    v_pk_mul_f32 v[86:87], v[86:87], v[84:85] op_sel:[0,0] op_sel_hi:[1,0] neg_hi:[0,1]
    v_pk_mul_f32 v[90:91], v[90:91], v[88:89] op_sel:[0,0] op_sel_hi:[1,0] neg_hi:[0,1]
    v_pk_mul_f32 v[94:95], v[94:95], v[92:93] op_sel:[0,0] op_sel_hi:[1,0] neg_hi:[0,1]
    v_mul_f32_dpp v96, v50, v82 row_newbcast:0 row_mask:0xf bank_mask:0xf
    v_mul_f32_dpp v97, v50, v83 row_newbcast:0 row_mask:0xf bank_mask:0xf
    s_nop 0
    v_fmac_f32_dpp v96, v52, v83 row_newbcast:0 row_mask:0xf bank_mask:0xf
    v_fmac_f32_dpp v97, v51, v82 row_newbcast:0 row_mask:0xf bank_mask:0xf
    v_mov_b32_dpp v118, v48 row_newbcast:1 row_mask:0xf bank_mask:0xf
    v_mov_b32_dpp v119, v49 row_newbcast:1 row_mask:0xf bank_mask:0xf
    v_pk_mul_f32 v[100:101], v[118:119], v[34:35] op_sel:[0,1] op_sel_hi:[1,1]
    v_pk_mul_f32 v[104:105], v[118:119], v[32:33] op_sel:[0,0] op_sel_hi:[1,0]
    v_pk_mul_f32 v[108:109], v[118:119], v[32:33] op_sel:[0,1] op_sel_hi:[1,1]
    v_pk_mul_f32 v[112:113], v[118:119], v[34:35] op_sel:[0,0] op_sel_hi:[1,0]
    v_fract_f32 v101, v101
    v_exp_f32 v100, v100
    v_fract_f32 v105, v105
    v_exp_f32 v104, v104
    v_fract_f32 v109, v109
    v_exp_f32 v108, v108
    v_fract_f32 v113, v113
    v_exp_f32 v112, v112
    v_cos_f32 v102, v101
    v_sin_f32 v103, v101
    v_cos_f32 v106, v105
    v_sin_f32 v107, v105
    v_cos_f32 v110, v109
    v_sin_f32 v111, v109
    v_cos_f32 v114, v113
    v_sin_f32 v115, v113
    v_pk_mul_f32 v[102:103], v[102:103], v[100:101] op_sel:[0,0] op_sel_hi:[1,0]
    v_pk_mul_f32 v[106:107], v[106:107], v[104:105] op_sel:[0,0] op_sel_hi:[1,0] neg_hi:[0,1]
    v_pk_mul_f32 v[110:111], v[110:111], v[108:109] op_sel:[0,0] op_sel_hi:[1,0] neg_hi:[0,1]
    v_pk_mul_f32 v[114:115], v[114:115], v[112:113] op_sel:[0,0] op_sel_hi:[1,0] neg_hi:[0,1]
    v_mul_f32_dpp v116, v50, v102 row_newbcast:1 row_mask:0xf bank_mask:0xf
    v_mul_f32_dpp v117, v50, v103 row_newbcast:1 row_mask:0xf bank_mask:0xf
    s_nop 0
    v_fmac_f32_dpp v116, v52, v103 row_newbcast:1 row_mask:0xf bank_mask:0xf
    v_fmac_f32_dpp v117, v51, v102 row_newbcast:1 row_mask:0xf bank_mask:0xf
    v_cvt_pk_f16_f32 v16, v86, v106
    v_cvt_pk_f16_f32 v20, v87, v107
    v_cvt_pk_f16_f32 v24, v90, v110
    v_cvt_pk_f16_f32 v28, v91, v111
    v_cvt_pk_f16_f32 v120, v94, v114
    v_cvt_pk_f16_f32 v124, v95, v115
    v_cvt_pk_f16_f32 v8, v96, v116
    v_cvt_pk_f16_f32 v12, v97, v117
    v_mov_b32_dpp v98, v48 row_newbcast:2 row_mask:0xf bank_mask:0xf
    v_mov_b32_dpp v99, v49 row_newbcast:2 row_mask:0xf bank_mask:0xf
    v_pk_mul_f32 v[80:81], v[98:99], v[34:35] op_sel:[0,1] op_sel_hi:[1,1]
    v_pk_mul_f32 v[84:85], v[98:99], v[32:33] op_sel:[0,0] op_sel_hi:[1,0]
    v_pk_mul_f32 v[88:89], v[98:99], v[32:33] op_sel:[0,1] op_sel_hi:[1,1]
    v_pk_mul_f32 v[92:93], v[98:99], v[34:35] op_sel:[0,0] op_sel_hi:[1,0]
    v_fract_f32 v81, v81
    v_exp_f32 v80, v80
    v_fract_f32 v85, v85
    v_exp_f32 v84, v84
    v_fract_f32 v89, v89
    v_exp_f32 v88, v88
    v_fract_f32 v93, v93
    v_exp_f32 v92, v92
    v_cos_f32 v82, v81
    v_sin_f32 v83, v81
    v_cos_f32 v86, v85
    v_sin_f32 v87, v85
    v_cos_f32 v90, v89
    v_sin_f32 v91, v89
    v_cos_f32 v94, v93
    v_sin_f32 v95, v93
    v_pk_mul_f32 v[82:83], v[82:83], v[80:81] op_sel:[0,0] op_sel_hi:[1,0]
    v_pk_mul_f32 v[86:87], v[86:87], v[84:85] op_sel:[0,0] op_sel_hi:[1,0] neg_hi:[0,1]
    v_pk_mul_f32 v[90:91], v[90:91], v[88:89] op_sel:[0,0] op_sel_hi:[1,0] neg_hi:[0,1]
    v_pk_mul_f32 v[94:95], v[94:95], v[92:93] op_sel:[0,0] op_sel_hi:[1,0] neg_hi:[0,1]
    v_mul_f32_dpp v96, v50, v82 row_newbcast:2 row_mask:0xf bank_mask:0xf
    v_mul_f32_dpp v97, v50, v83 row_newbcast:2 row_mask:0xf bank_mask:0xf
    s_nop 0
    v_fmac_f32_dpp v96, v52, v83 row_newbcast:2 row_mask:0xf bank_mask:0xf
    v_fmac_f32_dpp v97, v51, v82 row_newbcast:2 row_mask:0xf bank_mask:0xf
    v_mov_b32_dpp v118, v48 row_newbcast:3 row_mask:0xf bank_mask:0xf
    v_mov_b32_dpp v119, v49 row_newbcast:3 row_mask:0xf bank_mask:0xf
    v_pk_mul_f32 v[100:101], v[118:119], v[34:35] op_sel:[0,1] op_sel_hi:[1,1]
    v_pk_mul_f32 v[104:105], v[118:119], v[32:33] op_sel:[0,0] op_sel_hi:[1,0]
    v_pk_mul_f32 v[108:109], v[118:119], v[32:33] op_sel:[0,1] op_sel_hi:[1,1]
    v_pk_mul_f32 v[112:113], v[118:119], v[34:35] op_sel:[0,0] op_sel_hi:[1,0]
    v_fract_f32 v101, v101
    v_exp_f32 v100, v100
    v_fract_f32 v105, v105
    v_exp_f32 v104, v104
    v_fract_f32 v109, v109
    v_exp_f32 v108, v108
    v_fract_f32 v113, v113
    v_exp_f32 v112, v112
    v_cos_f32 v102, v101
    v_sin_f32 v103, v101
    v_cos_f32 v106, v105
    v_sin_f32 v107, v105
    v_cos_f32 v110, v109
    v_sin_f32 v111, v109
    v_cos_f32 v114, v113
    v_sin_f32 v115, v113
    v_pk_mul_f32 v[102:103], v[102:103], v[100:101] op_sel:[0,0] op_sel_hi:[1,0]
    v_pk_mul_f32 v[106:107], v[106:107], v[104:105] op_sel:[0,0] op_sel_hi:[1,0] neg_hi:[0,1]
    v_pk_mul_f32 v[110:111], v[110:111], v[108:109] op_sel:[0,0] op_sel_hi:[1,0] neg_hi:[0,1]
    v_pk_mul_f32 v[114:115], v[114:115], v[112:113] op_sel:[0,0] op_sel_hi:[1,0] neg_hi:[0,1]
    v_mul_f32_dpp v116, v50, v102 row_newbcast:3 row_mask:0xf bank_mask:0xf
    v_mul_f32_dpp v117, v50, v103 row_newbcast:3 row_mask:0xf bank_mask:0xf
    s_nop 0
    v_fmac_f32_dpp v116, v52, v103 row_newbcast:3 row_mask:0xf bank_mask:0xf
    v_fmac_f32_dpp v117, v51, v102 row_newbcast:3 row_mask:0xf bank_mask:0xf
    v_cvt_pk_f16_f32 v17, v86, v106
    v_cvt_pk_f16_f32 v21, v87, v107
    v_cvt_pk_f16_f32 v25, v90, v110
    v_cvt_pk_f16_f32 v29, v91, v111
    v_cvt_pk_f16_f32 v121, v94, v114
    v_cvt_pk_f16_f32 v125, v95, v115
    v_cvt_pk_f16_f32 v9, v96, v116
    v_cvt_pk_f16_f32 v13, v97, v117
    v_mov_b32_dpp v98, v48 row_newbcast:4 row_mask:0xf bank_mask:0xf
    v_mov_b32_dpp v99, v49 row_newbcast:4 row_mask:0xf bank_mask:0xf
    v_mfma_f32_16x16x16_f16 v[36:39], v[16:17], v[8:9], v[36:39]
    v_pk_mul_f32 v[80:81], v[98:99], v[34:35] op_sel:[0,1] op_sel_hi:[1,1]
    v_pk_mul_f32 v[84:85], v[98:99], v[32:33] op_sel:[0,0] op_sel_hi:[1,0]
    v_mfma_f32_16x16x16_f16 v[40:43], v[24:25], v[8:9], v[40:43]
    v_pk_mul_f32 v[88:89], v[98:99], v[32:33] op_sel:[0,1] op_sel_hi:[1,1]
    v_pk_mul_f32 v[92:93], v[98:99], v[34:35] op_sel:[0,0] op_sel_hi:[1,0]
    v_mfma_f32_16x16x16_f16 v[44:47], v[120:121], v[8:9], v[44:47]
    v_fract_f32 v81, v81
    v_exp_f32 v80, v80
    v_mfma_f32_16x16x16_f16 v[36:39], v[20:21], v[12:13], v[36:39]
    v_fract_f32 v85, v85
    v_exp_f32 v84, v84
    v_mfma_f32_16x16x16_f16 v[40:43], v[28:29], v[12:13], v[40:43]
    v_fract_f32 v89, v89
    v_exp_f32 v88, v88
    v_mfma_f32_16x16x16_f16 v[44:47], v[124:125], v[12:13], v[44:47]
    v_fract_f32 v93, v93
    v_exp_f32 v92, v92
    v_cos_f32 v82, v81
    v_sin_f32 v83, v81
    v_cos_f32 v86, v85
    v_sin_f32 v87, v85
    v_cos_f32 v90, v89
    v_sin_f32 v91, v89
    v_cos_f32 v94, v93
    v_sin_f32 v95, v93
    v_pk_mul_f32 v[82:83], v[82:83], v[80:81] op_sel:[0,0] op_sel_hi:[1,0]
    v_pk_mul_f32 v[86:87], v[86:87], v[84:85] op_sel:[0,0] op_sel_hi:[1,0] neg_hi:[0,1]
    v_pk_mul_f32 v[90:91], v[90:91], v[88:89] op_sel:[0,0] op_sel_hi:[1,0] neg_hi:[0,1]
    v_pk_mul_f32 v[94:95], v[94:95], v[92:93] op_sel:[0,0] op_sel_hi:[1,0] neg_hi:[0,1]
    v_mul_f32_dpp v96, v50, v82 row_newbcast:4 row_mask:0xf bank_mask:0xf
    v_mul_f32_dpp v97, v50, v83 row_newbcast:4 row_mask:0xf bank_mask:0xf
    s_nop 0
    v_fmac_f32_dpp v96, v52, v83 row_newbcast:4 row_mask:0xf bank_mask:0xf
    v_fmac_f32_dpp v97, v51, v82 row_newbcast:4 row_mask:0xf bank_mask:0xf
    v_mov_b32_dpp v118, v48 row_newbcast:5 row_mask:0xf bank_mask:0xf
    v_mov_b32_dpp v119, v49 row_newbcast:5 row_mask:0xf bank_mask:0xf
    v_pk_mul_f32 v[100:101], v[118:119], v[34:35] op_sel:[0,1] op_sel_hi:[1,1]
    v_pk_mul_f32 v[104:105], v[118:119], v[32:33] op_sel:[0,0] op_sel_hi:[1,0]
    v_pk_mul_f32 v[108:109], v[118:119], v[32:33] op_sel:[0,1] op_sel_hi:[1,1]
    v_pk_mul_f32 v[112:113], v[118:119], v[34:35] op_sel:[0,0] op_sel_hi:[1,0]
    v_fract_f32 v101, v101
    v_exp_f32 v100, v100
    v_fract_f32 v105, v105
    v_exp_f32 v104, v104
    v_fract_f32 v109, v109
    v_exp_f32 v108, v108
    v_fract_f32 v113, v113
    v_exp_f32 v112, v112
    v_cos_f32 v102, v101
    v_sin_f32 v103, v101
    v_cos_f32 v106, v105
    v_sin_f32 v107, v105
    v_cos_f32 v110, v109
    v_sin_f32 v111, v109
    v_cos_f32 v114, v113
    v_sin_f32 v115, v113
    v_pk_mul_f32 v[102:103], v[102:103], v[100:101] op_sel:[0,0] op_sel_hi:[1,0]
    v_pk_mul_f32 v[106:107], v[106:107], v[104:105] op_sel:[0,0] op_sel_hi:[1,0] neg_hi:[0,1]
    v_pk_mul_f32 v[110:111], v[110:111], v[108:109] op_sel:[0,0] op_sel_hi:[1,0] neg_hi:[0,1]
    v_pk_mul_f32 v[114:115], v[114:115], v[112:113] op_sel:[0,0] op_sel_hi:[1,0] neg_hi:[0,1]
    v_mul_f32_dpp v116, v50, v102 row_newbcast:5 row_mask:0xf bank_mask:0xf
    v_mul_f32_dpp v117, v50, v103 row_newbcast:5 row_mask:0xf bank_mask:0xf
    s_nop 0
    v_fmac_f32_dpp v116, v52, v103 row_newbcast:5 row_mask:0xf bank_mask:0xf
    v_fmac_f32_dpp v117, v51, v102 row_newbcast:5 row_mask:0xf bank_mask:0xf
    v_cvt_pk_f16_f32 v16, v86, v106
    v_cvt_pk_f16_f32 v20, v87, v107
    v_cvt_pk_f16_f32 v24, v90, v110
    v_cvt_pk_f16_f32 v28, v91, v111
    v_cvt_pk_f16_f32 v120, v94, v114
    v_cvt_pk_f16_f32 v124, v95, v115
    v_cvt_pk_f16_f32 v8, v96, v116
    v_cvt_pk_f16_f32 v12, v97, v117
    v_mov_b32_dpp v98, v48 row_newbcast:6 row_mask:0xf bank_mask:0xf
    v_mov_b32_dpp v99, v49 row_newbcast:6 row_mask:0xf bank_mask:0xf
    v_pk_mul_f32 v[80:81], v[98:99], v[34:35] op_sel:[0,1] op_sel_hi:[1,1]
    v_pk_mul_f32 v[84:85], v[98:99], v[32:33] op_sel:[0,0] op_sel_hi:[1,0]
    v_pk_mul_f32 v[88:89], v[98:99], v[32:33] op_sel:[0,1] op_sel_hi:[1,1]
    v_pk_mul_f32 v[92:93], v[98:99], v[34:35] op_sel:[0,0] op_sel_hi:[1,0]
    v_fract_f32 v81, v81
    v_exp_f32 v80, v80
    v_fract_f32 v85, v85
    v_exp_f32 v84, v84
    v_fract_f32 v89, v89
    v_exp_f32 v88, v88
    v_fract_f32 v93, v93
    v_exp_f32 v92, v92
    v_cos_f32 v82, v81
    v_sin_f32 v83, v81
    v_cos_f32 v86, v85
    v_sin_f32 v87, v85
    v_cos_f32 v90, v89
    v_sin_f32 v91, v89
    v_cos_f32 v94, v93
    v_sin_f32 v95, v93
    v_pk_mul_f32 v[82:83], v[82:83], v[80:81] op_sel:[0,0] op_sel_hi:[1,0]
    v_pk_mul_f32 v[86:87], v[86:87], v[84:85] op_sel:[0,0] op_sel_hi:[1,0] neg_hi:[0,1]
    v_pk_mul_f32 v[90:91], v[90:91], v[88:89] op_sel:[0,0] op_sel_hi:[1,0] neg_hi:[0,1]
    v_pk_mul_f32 v[94:95], v[94:95], v[92:93] op_sel:[0,0] op_sel_hi:[1,0] neg_hi:[0,1]
    v_mul_f32_dpp v96, v50, v82 row_newbcast:6 row_mask:0xf bank_mask:0xf
    v_mul_f32_dpp v97, v50, v83 row_newbcast:6 row_mask:0xf bank_mask:0xf
    s_nop 0
    v_fmac_f32_dpp v96, v52, v83 row_newbcast:6 row_mask:0xf bank_mask:0xf
    v_fmac_f32_dpp v97, v51, v82 row_newbcast:6 row_mask:0xf bank_mask:0xf
    v_mov_b32_dpp v118, v48 row_newbcast:7 row_mask:0xf bank_mask:0xf
    v_mov_b32_dpp v119, v49 row_newbcast:7 row_mask:0xf bank_mask:0xf
    v_pk_mul_f32 v[100:101], v[118:119], v[34:35] op_sel:[0,1] op_sel_hi:[1,1]
    v_pk_mul_f32 v[104:105], v[118:119], v[32:33] op_sel:[0,0] op_sel_hi:[1,0]
    v_pk_mul_f32 v[108:109], v[118:119], v[32:33] op_sel:[0,1] op_sel_hi:[1,1]
    v_pk_mul_f32 v[112:113], v[118:119], v[34:35] op_sel:[0,0] op_sel_hi:[1,0]
    v_fract_f32 v101, v101
    v_exp_f32 v100, v100
    v_fract_f32 v105, v105
    v_exp_f32 v104, v104
    v_fract_f32 v109, v109
    v_exp_f32 v108, v108
    v_fract_f32 v113, v113
    v_exp_f32 v112, v112
    v_cos_f32 v102, v101
    v_sin_f32 v103, v101
    v_cos_f32 v106, v105
    v_sin_f32 v107, v105
    v_cos_f32 v110, v109
    v_sin_f32 v111, v109
    v_cos_f32 v114, v113
    v_sin_f32 v115, v113
    v_pk_mul_f32 v[102:103], v[102:103], v[100:101] op_sel:[0,0] op_sel_hi:[1,0]
    v_pk_mul_f32 v[106:107], v[106:107], v[104:105] op_sel:[0,0] op_sel_hi:[1,0] neg_hi:[0,1]
    v_pk_mul_f32 v[110:111], v[110:111], v[108:109] op_sel:[0,0] op_sel_hi:[1,0] neg_hi:[0,1]
    v_pk_mul_f32 v[114:115], v[114:115], v[112:113] op_sel:[0,0] op_sel_hi:[1,0] neg_hi:[0,1]
    v_mul_f32_dpp v116, v50, v102 row_newbcast:7 row_mask:0xf bank_mask:0xf
    v_mul_f32_dpp v117, v50, v103 row_newbcast:7 row_mask:0xf bank_mask:0xf
    s_nop 0
    v_fmac_f32_dpp v116, v52, v103 row_newbcast:7 row_mask:0xf bank_mask:0xf
    v_fmac_f32_dpp v117, v51, v102 row_newbcast:7 row_mask:0xf bank_mask:0xf
    v_cvt_pk_f16_f32 v17, v86, v106
    v_cvt_pk_f16_f32 v21, v87, v107
    v_cvt_pk_f16_f32 v25, v90, v110
    v_cvt_pk_f16_f32 v29, v91, v111
    v_cvt_pk_f16_f32 v121, v94, v114
    v_cvt_pk_f16_f32 v125, v95, v115
    v_cvt_pk_f16_f32 v9, v96, v116
    v_cvt_pk_f16_f32 v13, v97, v117
    s_nop 0
    v_mfma_f32_16x16x16_f16 v[36:39], v[16:17], v[8:9], v[36:39]
    v_mfma_f32_16x16x16_f16 v[40:43], v[24:25], v[8:9], v[40:43]
    v_mfma_f32_16x16x16_f16 v[44:47], v[120:121], v[8:9], v[44:47]
    v_mfma_f32_16x16x16_f16 v[36:39], v[20:21], v[12:13], v[36:39]
    v_mfma_f32_16x16x16_f16 v[40:43], v[28:29], v[12:13], v[40:43]
    v_mfma_f32_16x16x16_f16 v[44:47], v[124:125], v[12:13], v[44:47]
    v_mul_u32_u24 v5, 768, v2
    v_lshl_add_u32 v5, v4, 6, v5
    v_add_u32 v5, v5, v3
    v_lshlrev_b32 v5, 2, v5
    s_nop 1
    ds_write_b32 v5, v36 offset:0
    ds_write_b32 v5, v37 offset:64
    ds_write_b32 v5, v38 offset:128
    ds_write_b32 v5, v39 offset:192
    ds_write_b32 v5, v40 offset:1024
    ds_write_b32 v5, v41 offset:1088
    ds_write_b32 v5, v42 offset:1152
    ds_write_b32 v5, v43 offset:1216
    ds_write_b32 v5, v44 offset:2048
    ds_write_b32 v5, v45 offset:2112
    ds_write_b32 v5, v46 offset:2176
    ds_write_b32 v5, v47 offset:2240
    v_lshlrev_b32 v5, 2, v0
    s_waitcnt lgkmcnt(0)
    s_barrier
    ds_read_b32 v8, v5 offset:0
    ds_read_b32 v9, v5 offset:3072
    ds_read_b32 v10, v5 offset:6144
    ds_read_b32 v11, v5 offset:9216
    ds_read_b32 v12, v5 offset:1024
    ds_read_b32 v13, v5 offset:4096
    ds_read_b32 v14, v5 offset:7168
    ds_read_b32 v15, v5 offset:10240
    ds_read_b32 v16, v5 offset:2048
    ds_read_b32 v17, v5 offset:5120
    ds_read_b32 v18, v5 offset:8192
    ds_read_b32 v19, v5 offset:11264
    s_lshl_b32 s4, s28, 12
    s_add_u32 s4, s4, 4194304
    v_lshlrev_b32 v6, 4, v0
    v_add_u32 v6, s4, v6
    s_waitcnt lgkmcnt(8)
    v_add_f32 v8, v8, v9
    v_add_f32 v10, v10, v11
    v_add_f32 v8, v8, v10
    v_mul_f32 v8, v7, v8
    v_cvt_pk_bf16_f32 v8, v8, v8
    ds_write_b16 v60, v8 offset:12288
    s_waitcnt lgkmcnt(5)
    v_add_f32 v12, v12, v13
    v_add_f32 v14, v14, v15
    v_add_f32 v12, v12, v14
    v_mul_f32 v12, v7, v12
    v_cvt_pk_bf16_f32 v12, v12, v12
    ds_write_b16 v61, v12 offset:12288
    s_waitcnt lgkmcnt(2)
    v_add_f32 v16, v16, v17
    v_add_f32 v18, v18, v19
    v_add_f32 v16, v16, v18
    v_mul_f32 v16, v7, v16
    v_cvt_pk_bf16_f32 v16, v16, v16
    ds_write_b16 v62, v16 offset:12288
    s_waitcnt lgkmcnt(0)
    s_barrier
    ds_read_u16 v24, v64 offset:12288
    ds_read_u16 v28, v65 offset:12288
    ds_read_u16 v25, v66 offset:12288
    ds_read_u16 v29, v67 offset:12288
    ds_read_u16 v26, v68 offset:12288
    ds_read_u16 v30, v69 offset:12288
    ds_read_u16 v27, v70 offset:12288
    ds_read_u16 v31, v71 offset:12288
    s_waitcnt lgkmcnt(6)
    v_lshl_or_b32 v24, v28, 16, v24
    s_waitcnt lgkmcnt(4)
    v_lshl_or_b32 v25, v29, 16, v25
    s_waitcnt lgkmcnt(2)
    v_lshl_or_b32 v26, v30, 16, v26
    s_waitcnt lgkmcnt(0)
    v_lshl_or_b32 v27, v31, 16, v27
    global_store_dwordx4 v6, v[24:27], s[22:23]
    s_endpgm
L_k1_ln:
    s_setprio 3
    s_load_dwordx2 s[4:5], s[0:1], 0
    s_load_dwordx2 s[6:7], s[0:1], 112
    s_sub_u32 s3, s2, 512
    s_and_b32 s8, s3, 7
    s_lshr_b32 s3, s3, 3
    s_lshl_b32 s8, s8, 8
    s_lshl_b32 s3, s3, 3
    s_add_u32 s3, s3, s8
    v_and_b32 v1, 63, v0
    v_lshrrev_b32 v2, 6, v0
    v_lshlrev_b32 v3, 1, v2
    v_add_u32 v3, s3, v3
    v_lshlrev_b32 v3, 10, v3
    v_lshl_add_u32 v3, v1, 4, v3
    s_waitcnt lgkmcnt(0)
    global_load_dwordx4 v[8:11], v3, s[4:5] offset:0
    global_load_dwordx4 v[12:15], v3, s[4:5] offset:1024
    s_mov_b32 s8, 0x3b000000
    s_mov_b32 s9, 0x3727c5ac
    v_lshlrev_b32 v5, 1, v2
    v_mul_u32_u24 v5, 1088, v5
    v_lshl_add_u32 v5, v1, 4, v5
    s_lshr_b32 s22, s3, 7
    s_lshl_b32 s22, s22, 17
    s_and_b32 s23, s3, 127
    s_lshl_b32 s23, s23, 6
    s_add_u32 s22, s22, s23
    s_lshr_b32 s23, s3, 2
    s_and_b32 s23, s23, 2
    v_lshrrev_b32 v4, 2, v1
    v_lshlrev_b32 v4, 13, v4
    v_lshl_add_u32 v4, v2, 7, v4
    v_lshrrev_b32 v6, 1, v2
    v_add_u32 v6, s23, v6
    v_xor_b32 v6, v1, v6
    v_and_b32 v6, 3, v6
    v_lshl_add_u32 v4, v6, 4, v4
    v_add_u32 v4, s22, v4
    v_and_b32 v6, 15, v1
    v_lshrrev_b32 v7, 4, v1
    v_lshrrev_b32 v60, 2, v6
    v_mul_u32_u24 v60, 1088, v60
    v_and_b32 v61, 3, v6
    v_lshlrev_b32 v61, 3, v61
    v_add_u32 v60, v60, v61
    v_lshlrev_b32 v61, 7, v2
    v_lshl_add_u32 v61, v7, 4, v61
    v_lshl_add_u32 v60, v61, 1, v60
    v_add_u32 v61, v61, v6
    v_lshlrev_b32 v61, 12, v61
    s_lshl_b32 s3, s3, 1
    s_add_u32 s3, s3, 2097152
    v_add_u32 v61, s3, v61
    v_add_u32 v62, 262144, v61
    s_waitcnt vmcnt(1)
    v_lshlrev_b32 v32, 16, v8
    v_and_b32 v33, 0xffff0000, v8
    v_lshlrev_b32 v34, 16, v9
    v_and_b32 v35, 0xffff0000, v9
    v_lshlrev_b32 v36, 16, v10
    v_and_b32 v37, 0xffff0000, v10
    v_lshlrev_b32 v38, 16, v11
    v_and_b32 v39, 0xffff0000, v11
    s_waitcnt vmcnt(0)
    v_lshlrev_b32 v40, 16, v12
    v_and_b32 v41, 0xffff0000, v12
    v_lshlrev_b32 v42, 16, v13
    v_and_b32 v43, 0xffff0000, v13
    v_lshlrev_b32 v44, 16, v14
    v_and_b32 v45, 0xffff0000, v14
    v_lshlrev_b32 v46, 16, v15
    v_and_b32 v47, 0xffff0000, v15
    v_pk_add_f32 v[16:17], v[32:33], v[34:35]
    v_pk_add_f32 v[18:19], v[36:37], v[38:39]
    v_pk_add_f32 v[20:21], v[40:41], v[42:43]
    v_pk_add_f32 v[22:23], v[44:45], v[46:47]
    v_pk_add_f32 v[16:17], v[16:17], v[18:19]
    v_pk_add_f32 v[20:21], v[20:21], v[22:23]
    v_add_f32 v24, v16, v17
    v_add_f32 v25, v20, v21
    s_nop 0
    v_add_f32_dpp v24, v24, v24 row_shr:1 row_mask:0xf bank_mask:0xf bound_ctrl:0
    v_add_f32_dpp v25, v25, v25 row_shr:1 row_mask:0xf bank_mask:0xf bound_ctrl:0
    s_nop 0
    v_add_f32_dpp v24, v24, v24 row_shr:2 row_mask:0xf bank_mask:0xf bound_ctrl:0
    v_add_f32_dpp v25, v25, v25 row_shr:2 row_mask:0xf bank_mask:0xf bound_ctrl:0
    s_nop 0
    v_add_f32_dpp v24, v24, v24 row_shr:4 row_mask:0xf bank_mask:0xf bound_ctrl:0
    v_add_f32_dpp v25, v25, v25 row_shr:4 row_mask:0xf bank_mask:0xf bound_ctrl:0
    s_nop 0
    v_add_f32_dpp v24, v24, v24 row_shr:8 row_mask:0xf bank_mask:0xf bound_ctrl:0
    v_add_f32_dpp v25, v25, v25 row_shr:8 row_mask:0xf bank_mask:0xf bound_ctrl:0
    s_nop 0
    v_add_f32_dpp v24, v24, v24 row_bcast:15 row_mask:0xa bank_mask:0xf
    v_add_f32_dpp v25, v25, v25 row_bcast:15 row_mask:0xa bank_mask:0xf
    s_nop 0
    v_add_f32_dpp v24, v24, v24 row_bcast:31 row_mask:0xc bank_mask:0xf
    v_add_f32_dpp v25, v25, v25 row_bcast:31 row_mask:0xc bank_mask:0xf
    v_mul_f32 v24, s8, v24
    v_mul_f32 v25, s8, v25
    v_readlane_b32 s10, v24, 63
    v_readlane_b32 s12, v25, 63
    s_nop 0
    v_pk_add_f32 v[64:65], v[32:33], s[10:11] op_sel_hi:[1,0] neg_lo:[0,1] neg_hi:[0,1]
    v_pk_add_f32 v[66:67], v[34:35], s[10:11] op_sel_hi:[1,0] neg_lo:[0,1] neg_hi:[0,1]
    v_pk_add_f32 v[68:69], v[36:37], s[10:11] op_sel_hi:[1,0] neg_lo:[0,1] neg_hi:[0,1]
    v_pk_add_f32 v[70:71], v[38:39], s[10:11] op_sel_hi:[1,0] neg_lo:[0,1] neg_hi:[0,1]
    v_pk_add_f32 v[72:73], v[40:41], s[12:13] op_sel_hi:[1,0] neg_lo:[0,1] neg_hi:[0,1]
    v_pk_add_f32 v[74:75], v[42:43], s[12:13] op_sel_hi:[1,0] neg_lo:[0,1] neg_hi:[0,1]
    v_pk_add_f32 v[76:77], v[44:45], s[12:13] op_sel_hi:[1,0] neg_lo:[0,1] neg_hi:[0,1]
    v_pk_add_f32 v[78:79], v[46:47], s[12:13] op_sel_hi:[1,0] neg_lo:[0,1] neg_hi:[0,1]
    v_pk_mul_f32 v[16:17], v[64:65], v[64:65]
    v_pk_mul_f32 v[18:19], v[66:67], v[66:67]
    v_pk_mul_f32 v[20:21], v[72:73], v[72:73]
    v_pk_mul_f32 v[22:23], v[74:75], v[74:75]
    v_pk_fma_f32 v[16:17], v[68:69], v[68:69], v[16:17]
    v_pk_fma_f32 v[18:19], v[70:71], v[70:71], v[18:19]
    v_pk_fma_f32 v[20:21], v[76:77], v[76:77], v[20:21]
    v_pk_fma_f32 v[22:23], v[78:79], v[78:79], v[22:23]
    v_pk_add_f32 v[16:17], v[16:17], v[18:19]
    v_pk_add_f32 v[20:21], v[20:21], v[22:23]
    v_add_f32 v28, v16, v17
    v_add_f32 v29, v20, v21
    s_nop 0
    v_add_f32_dpp v28, v28, v28 row_shr:1 row_mask:0xf bank_mask:0xf bound_ctrl:0
    v_add_f32_dpp v29, v29, v29 row_shr:1 row_mask:0xf bank_mask:0xf bound_ctrl:0
    s_nop 0
    v_add_f32_dpp v28, v28, v28 row_shr:2 row_mask:0xf bank_mask:0xf bound_ctrl:0
    v_add_f32_dpp v29, v29, v29 row_shr:2 row_mask:0xf bank_mask:0xf bound_ctrl:0
    s_nop 0
    v_add_f32_dpp v28, v28, v28 row_shr:4 row_mask:0xf bank_mask:0xf bound_ctrl:0
    v_add_f32_dpp v29, v29, v29 row_shr:4 row_mask:0xf bank_mask:0xf bound_ctrl:0
    s_nop 0
    v_add_f32_dpp v28, v28, v28 row_shr:8 row_mask:0xf bank_mask:0xf bound_ctrl:0
    v_add_f32_dpp v29, v29, v29 row_shr:8 row_mask:0xf bank_mask:0xf bound_ctrl:0
    s_nop 0
    v_add_f32_dpp v28, v28, v28 row_bcast:15 row_mask:0xa bank_mask:0xf
    v_add_f32_dpp v29, v29, v29 row_bcast:15 row_mask:0xa bank_mask:0xf
    s_nop 0
    v_add_f32_dpp v28, v28, v28 row_bcast:31 row_mask:0xc bank_mask:0xf
    v_add_f32_dpp v29, v29, v29 row_bcast:31 row_mask:0xc bank_mask:0xf
    v_mul_f32 v28, s8, v28
    v_mul_f32 v29, s8, v29
    v_cvt_pk_bf16_f32 v28, v28, v24
    v_cvt_pk_bf16_f32 v29, v29, v25
    v_and_b32 v24, 0xffff0000, v28
    v_lshlrev_b32 v28, 16, v28
    v_and_b32 v25, 0xffff0000, v29
    v_lshlrev_b32 v29, 16, v29
    v_add_f32 v28, s9, v28
    v_add_f32 v29, s9, v29
    v_cvt_pk_bf16_f32 v28, v28, v28
    v_cvt_pk_bf16_f32 v29, v29, v29
    v_lshlrev_b32 v28, 16, v28
    v_lshlrev_b32 v29, 16, v29
    v_sqrt_f32 v28, v28
    v_sqrt_f32 v29, v29
    v_cvt_pk_bf16_f32 v28, v28, v28
    v_cvt_pk_bf16_f32 v29, v29, v29
    v_lshlrev_b32 v28, 16, v28
    v_lshlrev_b32 v29, 16, v29
    v_rcp_f32 v26, v28
    v_rcp_f32 v27, v29
    v_readlane_b32 s10, v24, 63
    v_readlane_b32 s14, v28, 63
    v_readlane_b32 s18, v26, 63
    v_readlane_b32 s12, v25, 63
    v_readlane_b32 s16, v29, 63
    v_readlane_b32 s20, v27, 63
    v_pk_add_f32 v[32:33], v[32:33], s[10:11] op_sel_hi:[1,0] neg_lo:[0,1] neg_hi:[0,1]
    v_pk_add_f32 v[34:35], v[34:35], s[10:11] op_sel_hi:[1,0] neg_lo:[0,1] neg_hi:[0,1]
    v_pk_add_f32 v[36:37], v[36:37], s[10:11] op_sel_hi:[1,0] neg_lo:[0,1] neg_hi:[0,1]
    v_pk_add_f32 v[38:39], v[38:39], s[10:11] op_sel_hi:[1,0] neg_lo:[0,1] neg_hi:[0,1]
    v_pk_add_f32 v[40:41], v[40:41], s[12:13] op_sel_hi:[1,0] neg_lo:[0,1] neg_hi:[0,1]
    v_pk_add_f32 v[42:43], v[42:43], s[12:13] op_sel_hi:[1,0] neg_lo:[0,1] neg_hi:[0,1]
    v_pk_add_f32 v[44:45], v[44:45], s[12:13] op_sel_hi:[1,0] neg_lo:[0,1] neg_hi:[0,1]
    v_pk_add_f32 v[46:47], v[46:47], s[12:13] op_sel_hi:[1,0] neg_lo:[0,1] neg_hi:[0,1]
    v_cvt_pk_bf16_f32 v16, v32, v33
    v_cvt_pk_bf16_f32 v17, v34, v35
    v_cvt_pk_bf16_f32 v18, v36, v37
    v_cvt_pk_bf16_f32 v19, v38, v39
    v_cvt_pk_bf16_f32 v20, v40, v41
    v_cvt_pk_bf16_f32 v21, v42, v43
    v_cvt_pk_bf16_f32 v22, v44, v45
    v_cvt_pk_bf16_f32 v23, v46, v47
    v_lshlrev_b32 v32, 16, v16
    v_and_b32 v33, 0xffff0000, v16
    v_lshlrev_b32 v34, 16, v17
    v_and_b32 v35, 0xffff0000, v17
    v_lshlrev_b32 v36, 16, v18
    v_and_b32 v37, 0xffff0000, v18
    v_lshlrev_b32 v38, 16, v19
    v_and_b32 v39, 0xffff0000, v19
    v_lshlrev_b32 v40, 16, v20
    v_and_b32 v41, 0xffff0000, v20
    v_lshlrev_b32 v42, 16, v21
    v_and_b32 v43, 0xffff0000, v21
    v_lshlrev_b32 v44, 16, v22
    v_and_b32 v45, 0xffff0000, v22
    v_lshlrev_b32 v46, 16, v23
    v_and_b32 v47, 0xffff0000, v23
    v_pk_mul_f32 v[64:65], v[32:33], s[18:19] op_sel_hi:[1,0]
    v_pk_mul_f32 v[66:67], v[34:35], s[18:19] op_sel_hi:[1,0]
    v_pk_mul_f32 v[68:69], v[36:37], s[18:19] op_sel_hi:[1,0]
    v_pk_mul_f32 v[70:71], v[38:39], s[18:19] op_sel_hi:[1,0]
    v_pk_mul_f32 v[72:73], v[40:41], s[20:21] op_sel_hi:[1,0]
    v_pk_mul_f32 v[74:75], v[42:43], s[20:21] op_sel_hi:[1,0]
    v_pk_mul_f32 v[76:77], v[44:45], s[20:21] op_sel_hi:[1,0]
    v_pk_mul_f32 v[78:79], v[46:47], s[20:21] op_sel_hi:[1,0]
    v_pk_fma_f32 v[32:33], v[64:65], s[14:15], v[32:33] op_sel_hi:[1,0,1] neg_lo:[1,0,0] neg_hi:[1,0,0]
    v_pk_fma_f32 v[34:35], v[66:67], s[14:15], v[34:35] op_sel_hi:[1,0,1] neg_lo:[1,0,0] neg_hi:[1,0,0]
    v_pk_fma_f32 v[36:37], v[68:69], s[14:15], v[36:37] op_sel_hi:[1,0,1] neg_lo:[1,0,0] neg_hi:[1,0,0]
    v_pk_fma_f32 v[38:39], v[70:71], s[14:15], v[38:39] op_sel_hi:[1,0,1] neg_lo:[1,0,0] neg_hi:[1,0,0]
    v_pk_fma_f32 v[40:41], v[72:73], s[16:17], v[40:41] op_sel_hi:[1,0,1] neg_lo:[1,0,0] neg_hi:[1,0,0]
    v_pk_fma_f32 v[42:43], v[74:75], s[16:17], v[42:43] op_sel_hi:[1,0,1] neg_lo:[1,0,0] neg_hi:[1,0,0]
    v_pk_fma_f32 v[44:45], v[76:77], s[16:17], v[44:45] op_sel_hi:[1,0,1] neg_lo:[1,0,0] neg_hi:[1,0,0]
    v_pk_fma_f32 v[46:47], v[78:79], s[16:17], v[46:47] op_sel_hi:[1,0,1] neg_lo:[1,0,0] neg_hi:[1,0,0]
    v_pk_fma_f32 v[64:65], v[32:33], s[18:19], v[64:65] op_sel_hi:[1,0,1]
    v_pk_fma_f32 v[66:67], v[34:35], s[18:19], v[66:67] op_sel_hi:[1,0,1]
    v_pk_fma_f32 v[68:69], v[36:37], s[18:19], v[68:69] op_sel_hi:[1,0,1]
    v_pk_fma_f32 v[70:71], v[38:39], s[18:19], v[70:71] op_sel_hi:[1,0,1]
    v_pk_fma_f32 v[72:73], v[40:41], s[20:21], v[72:73] op_sel_hi:[1,0,1]
    v_pk_fma_f32 v[74:75], v[42:43], s[20:21], v[74:75] op_sel_hi:[1,0,1]
    v_pk_fma_f32 v[76:77], v[44:45], s[20:21], v[76:77] op_sel_hi:[1,0,1]
    v_pk_fma_f32 v[78:79], v[46:47], s[20:21], v[78:79] op_sel_hi:[1,0,1]
    v_cvt_pk_bf16_f32 v8, v64, v65
    v_cvt_pk_bf16_f32 v9, v66, v67
    v_cvt_pk_bf16_f32 v10, v68, v69
    v_cvt_pk_bf16_f32 v11, v70, v71
    v_cvt_pk_bf16_f32 v12, v72, v73
    v_cvt_pk_bf16_f32 v13, v74, v75
    v_cvt_pk_bf16_f32 v14, v76, v77
    v_cvt_pk_bf16_f32 v15, v78, v79
    ds_write_b128 v5, v[8:11] offset:0
    global_store_dwordx4 v4, v[8:11], s[6:7] offset:0
    ds_write_b128 v5, v[12:15] offset:1088
    global_store_dwordx4 v4, v[12:15], s[6:7] offset:64
    s_waitcnt lgkmcnt(0)
    s_barrier
    ds_read_b64_tr_b16 v[32:33], v60 offset:0
    ds_read_b64_tr_b16 v[34:35], v60 offset:4352
    ds_read_b64_tr_b16 v[36:37], v60 offset:128
    ds_read_b64_tr_b16 v[38:39], v60 offset:4480
    s_waitcnt lgkmcnt(2)
    global_store_dwordx4 v61, v[32:35], s[6:7]
    s_waitcnt lgkmcnt(0)
    global_store_dwordx4 v62, v[36:39], s[6:7]
    s_endpgm
L_k1_pf:
    s_load_dwordx4 s[4:7], s[0:1], 80
    s_sub_u32 s14, s2, 768
    s_lshr_b32 s3, s14, 3
    s_lshl_b32 s3, s3, 16
    v_lshlrev_b32 v1, 4, v0
    s_lshl_b32 s14, s14, 12
    s_waitcnt lgkmcnt(0)
    s_mov_b32 s16, s4
    s_and_b32 s17, s5, 0xffff
    s_mov_b32 s18, 1409024
    s_mov_b32 s19, 0x00020000
    s_mov_b32 s20, s6
    s_and_b32 s21, s7, 0xffff
    s_mov_b32 s22, 1409024
    s_mov_b32 s23, 0x00020000
    s_add_u32 s24, s3, 0
    buffer_load_dwordx4 v[8:11], v1, s[16:19], s24 offen
    s_add_u32 s24, s3, 4096
    buffer_load_dwordx4 v[12:15], v1, s[16:19], s24 offen
    s_add_u32 s24, s3, 8192
    buffer_load_dwordx4 v[16:19], v1, s[16:19], s24 offen
    s_add_u32 s24, s3, 12288
    buffer_load_dwordx4 v[20:23], v1, s[16:19], s24 offen
    s_add_u32 s24, s3, 16384
    buffer_load_dwordx4 v[24:27], v1, s[16:19], s24 offen
    s_add_u32 s24, s3, 20480
    buffer_load_dwordx4 v[28:31], v1, s[16:19], s24 offen
    s_add_u32 s24, s3, 24576
    buffer_load_dwordx4 v[32:35], v1, s[16:19], s24 offen
    s_add_u32 s24, s3, 28672
    buffer_load_dwordx4 v[36:39], v1, s[16:19], s24 offen
    s_add_u32 s24, s3, 32768
    buffer_load_dwordx4 v[40:43], v1, s[16:19], s24 offen
    s_add_u32 s24, s3, 36864
    buffer_load_dwordx4 v[44:47], v1, s[16:19], s24 offen
    s_add_u32 s24, s3, 40960
    buffer_load_dwordx4 v[48:51], v1, s[16:19], s24 offen
    s_add_u32 s24, s3, 45056
    buffer_load_dwordx4 v[52:55], v1, s[16:19], s24 offen
    s_add_u32 s24, s3, 49152
    buffer_load_dwordx4 v[56:59], v1, s[16:19], s24 offen
    s_add_u32 s24, s3, 53248
    buffer_load_dwordx4 v[60:63], v1, s[16:19], s24 offen
    s_add_u32 s24, s3, 57344
    buffer_load_dwordx4 v[64:67], v1, s[16:19], s24 offen
    s_add_u32 s24, s3, 61440
    buffer_load_dwordx4 v[68:71], v1, s[16:19], s24 offen
    buffer_load_dwordx4 v[72:75], v1, s[20:23], s14 offen
    s_add_u32 s14, s14, 720896
    buffer_load_dwordx4 v[76:79], v1, s[20:23], s14 offen
    s_waitcnt vmcnt(0)
L_k1_exit:
    s_endpgm
.p2align 8
.type mid_kernel,@function
mid_kernel:
    s_cmp_ge_u32 s2, 512
    s_cbranch_scc1 L_k2_exit
    s_cmp_ge_u32 s2, 176
    s_cbranch_scc1 L_k2_conv
    s_load_dwordx2 s[36:37], s[0:1], 104
    s_load_dwordx2 s[4:5], s[0:1], 80
    s_load_dwordx2 s[6:7], s[0:1], 112
    s_and_b32 s9, s2, 7
    s_lshr_b32 s8, s2, 4
    s_bfe_u32 s27, s2, 0x10003
    s_lshl_b32 s9, s9, 1
    s_add_u32 s9, s9, s27
    s_lshl_b32 s10, s8, 8
    s_lshl_b32 s11, s9, 17
    v_and_b32 v1, 63, v0
    v_lshrrev_b32 v2, 6, v0
    s_nop 0
    v_readfirstlane_b32 s12, v2
    v_and_b32 v2, 3, v2
    s_nop 0
    s_cmp_lt_u32 s12, 4
    s_cbranch_scc1 L_g1_c0
    s_and_b32 s12, s12, 3
    s_lshl_b32 s13, s12, 11
    v_lshlrev_b32 v3, 4, v1
    v_add_u32 v3, s13, v3
    v_add_u32 v8, s11, v3
    v_lshrrev_b32 v4, 4, v1
    v_lshl_add_u32 v5, v2, 3, v4
    v_mul_u32_u24 v5, 2752, v5
    v_lshlrev_b32 v4, 2, v4
    v_and_b32 v6, 15, v1
    v_xor_b32 v6, v6, v4
    v_lshl_add_u32 v5, v6, 4, v5
    v_add_u32 v10, s10, v5
    v_add_u32 v11, 9984, v10
    s_lshl_b32 s14, s9, 3
    v_mov_b32 v12, s14
    s_mul_i32 s15, s27, 704512
    s_waitcnt lgkmcnt(0)
    s_mov_b32 s16, s6
    s_and_b32 s17, s7, 0xffff
    s_mov_b32 s18, 67108864
    s_mov_b32 s19, 0x00020000
    s_mov_b32 s20, s4
    s_and_b32 s21, s5, 0xffff
    s_mov_b32 s22, 1409024
    s_mov_b32 s23, 0x00020000
    s_mov_b32 s25, 0
    s_mov_b32 s27, 0
    s_add_u32 s24, s13, 0
    s_mov_b32 m0, s24
    s_add_u32 s26, s13, 8192
    buffer_load_dwordx4 v8, s[16:19], s25 offen offset:0 lds
    buffer_load_dwordx4 v8, s[16:19], s25 offen offset:1024 lds
    s_mov_b32 m0, s26
    s_nop 0
    buffer_load_dwordx4 v10, s[20:23], s27 offen lds
    buffer_load_dwordx4 v11, s[20:23], s27 offen offset:1024 lds
    s_mov_b32 s25, 8192
    s_mov_b32 s27, 88064
    s_add_u32 s24, s13, 16384
    s_mov_b32 m0, s24
    s_add_u32 s26, s13, 24576
    buffer_load_dwordx4 v8, s[16:19], s25 offen offset:0 lds
    buffer_load_dwordx4 v8, s[16:19], s25 offen offset:1024 lds
    s_mov_b32 m0, s26
    s_nop 0
    buffer_load_dwordx4 v10, s[20:23], s27 offen lds
    buffer_load_dwordx4 v11, s[20:23], s27 offen offset:1024 lds
    s_waitcnt vmcnt(4)
    s_barrier
    s_mov_b32 s25, 16384
    s_mov_b32 s27, 176128
    s_add_u32 s24, s13, 32768
    s_mov_b32 m0, s24
    s_add_u32 s26, s13, 40960
    buffer_load_dwordx4 v8, s[16:19], s25 offen offset:0 lds
    buffer_load_dwordx4 v8, s[16:19], s25 offen offset:1024 lds
    s_mov_b32 m0, s26
    s_nop 0
    buffer_load_dwordx4 v10, s[20:23], s27 offen lds
    buffer_load_dwordx4 v11, s[20:23], s27 offen offset:1024 lds
    s_mov_b32 s25, 24576
    s_mov_b32 s27, 264192
    s_add_u32 s24, s13, 49152
    s_mov_b32 m0, s24
    s_add_u32 s26, s13, 57344
    buffer_load_dwordx4 v8, s[16:19], s25 offen offset:0 lds
    buffer_load_dwordx4 v8, s[16:19], s25 offen offset:1024 lds
    s_mov_b32 m0, s26
    s_nop 0
    buffer_load_dwordx4 v10, s[20:23], s27 offen lds
    buffer_load_dwordx4 v11, s[20:23], s27 offen offset:1024 lds
    s_waitcnt vmcnt(8)
    s_barrier
    s_mov_b32 s25, 32768
    s_mov_b32 s27, 352256
    s_add_u32 s24, s13, 65536
    s_mov_b32 m0, s24
    s_add_u32 s26, s13, 73728
    buffer_load_dwordx4 v8, s[16:19], s25 offen offset:0 lds
    buffer_load_dwordx4 v8, s[16:19], s25 offen offset:1024 lds
    s_mov_b32 m0, s26
    s_nop 0
    buffer_load_dwordx4 v10, s[20:23], s27 offen lds
    buffer_load_dwordx4 v11, s[20:23], s27 offen offset:1024 lds
    s_mov_b32 s25, 40960
    s_mov_b32 s27, 440320
    s_add_u32 s24, s13, 0
    s_mov_b32 m0, s24
    s_add_u32 s26, s13, 8192
    buffer_load_dwordx4 v8, s[16:19], s25 offen offset:0 lds
    buffer_load_dwordx4 v8, s[16:19], s25 offen offset:1024 lds
    s_mov_b32 m0, s26
    s_nop 0
    buffer_load_dwordx4 v10, s[20:23], s27 offen lds
    buffer_load_dwordx4 v11, s[20:23], s27 offen offset:1024 lds
    s_waitcnt vmcnt(12)
    s_barrier
    s_mov_b32 s25, 49152
    s_mov_b32 s27, 528384
    s_add_u32 s24, s13, 16384
    s_mov_b32 m0, s24
    s_add_u32 s26, s13, 24576
    buffer_load_dwordx4 v8, s[16:19], s25 offen offset:0 lds
    buffer_load_dwordx4 v8, s[16:19], s25 offen offset:1024 lds
    s_mov_b32 m0, s26
    s_nop 0
    buffer_load_dwordx4 v10, s[20:23], s27 offen lds
    buffer_load_dwordx4 v11, s[20:23], s27 offen offset:1024 lds
    s_waitcnt vmcnt(12)
    s_barrier
    s_mov_b32 s25, 57344
    s_mov_b32 s27, 616448
    s_add_u32 s24, s13, 32768
    s_mov_b32 m0, s24
    s_add_u32 s26, s13, 40960
    buffer_load_dwordx4 v8, s[16:19], s25 offen offset:0 lds
    buffer_load_dwordx4 v8, s[16:19], s25 offen offset:1024 lds
    s_mov_b32 m0, s26
    s_nop 0
    buffer_load_dwordx4 v10, s[20:23], s27 offen lds
    buffer_load_dwordx4 v11, s[20:23], s27 offen offset:1024 lds
    s_waitcnt vmcnt(12)
    s_barrier
    s_mov_b32 s25, 65536
    s_mov_b32 s27, 704512
    s_add_u32 s24, s13, 49152
    s_mov_b32 m0, s24
    s_add_u32 s26, s13, 57344
    buffer_load_dwordx4 v8, s[16:19], s25 offen offset:0 lds
    buffer_load_dwordx4 v8, s[16:19], s25 offen offset:1024 lds
    s_mov_b32 m0, s26
    s_nop 0
    buffer_load_dwordx4 v10, s[20:23], s27 offen lds
    buffer_load_dwordx4 v11, s[20:23], s27 offen offset:1024 lds
    s_waitcnt vmcnt(12)
    s_barrier
    s_mov_b32 s25, 73728
    s_mov_b32 s27, 792576
    s_add_u32 s24, s13, 65536
    s_mov_b32 m0, s24
    s_add_u32 s26, s13, 73728
    buffer_load_dwordx4 v8, s[16:19], s25 offen offset:0 lds
    buffer_load_dwordx4 v8, s[16:19], s25 offen offset:1024 lds
    s_mov_b32 m0, s26
    s_nop 0
    buffer_load_dwordx4 v10, s[20:23], s27 offen lds
    buffer_load_dwordx4 v11, s[20:23], s27 offen offset:1024 lds
    s_waitcnt vmcnt(12)
    s_barrier
    s_mov_b32 s25, 81920
    s_mov_b32 s27, 880640
    s_add_u32 s24, s13, 0
    s_mov_b32 m0, s24
    s_add_u32 s26, s13, 8192
    buffer_load_dwordx4 v8, s[16:19], s25 offen offset:0 lds
    buffer_load_dwordx4 v8, s[16:19], s25 offen offset:1024 lds
    s_mov_b32 m0, s26
    s_nop 0
    buffer_load_dwordx4 v10, s[20:23], s27 offen lds
    buffer_load_dwordx4 v11, s[20:23], s27 offen offset:1024 lds
    s_waitcnt vmcnt(12)
    s_barrier
    s_mov_b32 s25, 90112
    s_mov_b32 s27, 968704
    s_add_u32 s24, s13, 16384
    s_mov_b32 m0, s24
    s_add_u32 s26, s13, 24576
    buffer_load_dwordx4 v8, s[16:19], s25 offen offset:0 lds
    buffer_load_dwordx4 v8, s[16:19], s25 offen offset:1024 lds
    s_mov_b32 m0, s26
    s_nop 0
    buffer_load_dwordx4 v10, s[20:23], s27 offen lds
    buffer_load_dwordx4 v11, s[20:23], s27 offen offset:1024 lds
    s_waitcnt vmcnt(12)
    s_barrier
    s_mov_b32 s25, 98304
    s_mov_b32 s27, 1056768
    s_add_u32 s24, s13, 32768
    s_mov_b32 m0, s24
    s_add_u32 s26, s13, 40960
    buffer_load_dwordx4 v8, s[16:19], s25 offen offset:0 lds
    buffer_load_dwordx4 v8, s[16:19], s25 offen offset:1024 lds
    s_mov_b32 m0, s26
    s_nop 0
    buffer_load_dwordx4 v10, s[20:23], s27 offen lds
    buffer_load_dwordx4 v11, s[20:23], s27 offen offset:1024 lds
    s_waitcnt vmcnt(12)
    s_barrier
    s_mov_b32 s25, 106496
    s_mov_b32 s27, 1144832
    s_add_u32 s24, s13, 49152
    s_mov_b32 m0, s24
    s_add_u32 s26, s13, 57344
    buffer_load_dwordx4 v8, s[16:19], s25 offen offset:0 lds
    buffer_load_dwordx4 v8, s[16:19], s25 offen offset:1024 lds
    s_mov_b32 m0, s26
    s_nop 0
    buffer_load_dwordx4 v10, s[20:23], s27 offen lds
    buffer_load_dwordx4 v11, s[20:23], s27 offen offset:1024 lds
    s_waitcnt vmcnt(12)
    s_barrier
    s_mov_b32 s25, 114688
    s_mov_b32 s27, 1232896
    s_add_u32 s24, s13, 65536
    s_mov_b32 m0, s24
    s_add_u32 s26, s13, 73728
    buffer_load_dwordx4 v8, s[16:19], s25 offen offset:0 lds
    buffer_load_dwordx4 v8, s[16:19], s25 offen offset:1024 lds
    s_mov_b32 m0, s26
    s_nop 0
    buffer_load_dwordx4 v10, s[20:23], s27 offen lds
    buffer_load_dwordx4 v11, s[20:23], s27 offen offset:1024 lds
    s_waitcnt vmcnt(12)
    s_barrier
    s_mov_b32 s25, 122880
    s_mov_b32 s27, 1320960
    s_add_u32 s24, s13, 0
    s_mov_b32 m0, s24
    s_add_u32 s26, s13, 8192
    buffer_load_dwordx4 v8, s[16:19], s25 offen offset:0 lds
    buffer_load_dwordx4 v8, s[16:19], s25 offen offset:1024 lds
    s_mov_b32 m0, s26
    s_nop 0
    buffer_load_dwordx4 v10, s[20:23], s27 offen lds
    buffer_load_dwordx4 v11, s[20:23], s27 offen offset:1024 lds
    s_waitcnt vmcnt(12)
    s_barrier
    s_waitcnt vmcnt(8)
    s_barrier
    s_waitcnt vmcnt(4)
    s_barrier
    s_waitcnt vmcnt(0)
    s_barrier
    s_endpgm
L_g1_c0:
    s_nop 3
L_g1_comp:
    s_nop 3
    v_and_b32 v4, 31, v1
    v_lshrrev_b32 v5, 5, v1
    v_and_b32 v6, 1, v2
    v_lshl_add_u32 v4, v6, 6, v4
    v_lshrrev_b32 v6, 2, v4
    v_and_b32 v6, 3, v6
    v_add_u32 v7, 0, v5
    v_xor_b32 v7, v7, v6
    v_lshlrev_b32 v7, 4, v7
    v_lshl_add_u32 v8, v4, 6, v7
    v_add_u32 v7, 2, v5
    v_xor_b32 v7, v7, v6
    v_lshlrev_b32 v7, 4, v7
    v_lshl_add_u32 v9, v4, 6, v7
    v_and_b32 v4, 15, v1
    v_lshrrev_b32 v5, 4, v1
    v_lshrrev_b32 v6, 1, v5
    v_lshrrev_b32 v7, 2, v4
    v_lshl_add_u32 v3, v6, 3, v7
    v_lshlrev_b32 v3, 8, v3
    v_and_b32 v6, 1, v4
    v_lshl_add_u32 v3, v6, 3, v3
    v_add_u32 v3, 8192, v3
    v_and_b32 v5, 1, v5
    v_lshlrev_b32 v5, 1, v5
    v_bfe_u32 v6, v4, 1, 1
    v_add_u32 v5, v5, v6
    v_lshrrev_b32 v6, 1, v2
    v_lshl_add_u32 v5, v6, 3, v5
    v_lshlrev_b32 v7, 2, v7
    v_add_u32 v6, 0, v5
    v_xor_b32 v6, v6, v7
    v_lshl_add_u32 v10, v6, 4, v3
    v_add_u32 v6, 4, v5
    v_xor_b32 v6, v6, v7
    v_lshl_add_u32 v11, v6, 4, v3
    v_add_u32 v12, 49152, v8
    v_add_u32 v13, 49152, v9
    v_add_u32 v14, 49152, v10
    v_add_u32 v15, 49152, v11
    v_mov_b32 v16, 0
    v_mov_b32 v17, 0
    v_mov_b32 v18, 0
    v_mov_b32 v19, 0
    v_mov_b32 v20, 0
    v_mov_b32 v21, 0
    v_mov_b32 v22, 0
    v_mov_b32 v23, 0
    v_mov_b32 v24, 0
    v_mov_b32 v25, 0
    v_mov_b32 v26, 0
    v_mov_b32 v27, 0
    v_mov_b32 v28, 0
    v_mov_b32 v29, 0
    v_mov_b32 v30, 0
    v_mov_b32 v31, 0
    v_mov_b32 v32, 0
    v_mov_b32 v33, 0
    v_mov_b32 v34, 0
    v_mov_b32 v35, 0
    v_mov_b32 v36, 0
    v_mov_b32 v37, 0
    v_mov_b32 v38, 0
    v_mov_b32 v39, 0
    v_mov_b32 v40, 0
    v_mov_b32 v41, 0
    v_mov_b32 v42, 0
    v_mov_b32 v43, 0
    v_mov_b32 v44, 0
    v_mov_b32 v45, 0
    v_mov_b32 v46, 0
    v_mov_b32 v47, 0
    v_mov_b32 v48, 0
    v_mov_b32 v49, 0
    v_mov_b32 v50, 0
    v_mov_b32 v51, 0
    v_mov_b32 v52, 0
    v_mov_b32 v53, 0
    v_mov_b32 v54, 0
    v_mov_b32 v55, 0
    v_mov_b32 v56, 0
    v_mov_b32 v57, 0
    v_mov_b32 v58, 0
    v_mov_b32 v59, 0
    v_mov_b32 v60, 0
    v_mov_b32 v61, 0
    v_mov_b32 v62, 0
    v_mov_b32 v63, 0
    v_mov_b32 v64, 0
    v_mov_b32 v65, 0
    v_mov_b32 v66, 0
    v_mov_b32 v67, 0
    v_mov_b32 v68, 0
    v_mov_b32 v69, 0
    v_mov_b32 v70, 0
    v_mov_b32 v71, 0
    v_mov_b32 v72, 0
    v_mov_b32 v73, 0
    v_mov_b32 v74, 0
    v_mov_b32 v75, 0
    v_mov_b32 v76, 0
    v_mov_b32 v77, 0
    v_mov_b32 v78, 0
    v_mov_b32 v79, 0
    s_waitcnt lgkmcnt(0)
    s_barrier
    ds_read_b128 v[80:83], v8 offset:0
    ds_read_b128 v[84:87], v8 offset:2048
    ds_read_b64_tr_b16 v[88:89], v10 offset:0
    ds_read_b64_tr_b16 v[90:91], v10 offset:1024
    ds_read_b64_tr_b16 v[92:93], v11 offset:0
    ds_read_b64_tr_b16 v[94:95], v11 offset:1024
    ds_read_b128 v[96:99], v9 offset:0
    ds_read_b128 v[100:103], v9 offset:2048
    ds_read_b64_tr_b16 v[104:105], v10 offset:4096
    ds_read_b64_tr_b16 v[106:107], v10 offset:5120
    ds_read_b64_tr_b16 v[108:109], v11 offset:4096
    ds_read_b64_tr_b16 v[110:111], v11 offset:5120
    s_waitcnt lgkmcnt(6)
    v_mfma_f32_32x32x16_bf16 v[16:31], v[88:91], v[80:83], v[16:31]
    v_mfma_f32_32x32x16_bf16 v[48:63], v[88:91], v[84:87], v[48:63]
    v_mfma_f32_32x32x16_bf16 v[32:47], v[92:95], v[80:83], v[32:47]
    v_mfma_f32_32x32x16_bf16 v[64:79], v[92:95], v[84:87], v[64:79]
    s_waitcnt lgkmcnt(0)
    s_barrier
    v_mfma_f32_32x32x16_bf16 v[16:31], v[104:107], v[96:99], v[16:31]
    ds_read_b128 v[112:115], v8 offset:16384
    ds_read_b128 v[116:119], v8 offset:18432
    ds_read_b64_tr_b16 v[120:121], v10 offset:16384
    v_mfma_f32_32x32x16_bf16 v[48:63], v[104:107], v[100:103], v[48:63]
    ds_read_b64_tr_b16 v[122:123], v10 offset:17408
    ds_read_b64_tr_b16 v[124:125], v11 offset:16384
    ds_read_b64_tr_b16 v[126:127], v11 offset:17408
    v_mfma_f32_32x32x16_bf16 v[32:47], v[108:111], v[96:99], v[32:47]
    ds_read_b128 v[80:83], v9 offset:16384
    ds_read_b128 v[84:87], v9 offset:18432
    ds_read_b64_tr_b16 v[88:89], v10 offset:20480
    v_mfma_f32_32x32x16_bf16 v[64:79], v[108:111], v[100:103], v[64:79]
    ds_read_b64_tr_b16 v[90:91], v10 offset:21504
    ds_read_b64_tr_b16 v[92:93], v11 offset:20480
    ds_read_b64_tr_b16 v[94:95], v11 offset:21504
    s_waitcnt lgkmcnt(6)
    v_mfma_f32_32x32x16_bf16 v[16:31], v[120:123], v[112:115], v[16:31]
    v_mfma_f32_32x32x16_bf16 v[48:63], v[120:123], v[116:119], v[48:63]
    v_mfma_f32_32x32x16_bf16 v[32:47], v[124:127], v[112:115], v[32:47]
    v_mfma_f32_32x32x16_bf16 v[64:79], v[124:127], v[116:119], v[64:79]
    s_waitcnt lgkmcnt(0)
    s_barrier
    v_mfma_f32_32x32x16_bf16 v[16:31], v[88:91], v[80:83], v[16:31]
    ds_read_b128 v[96:99], v8 offset:32768
    ds_read_b128 v[100:103], v8 offset:34816
    ds_read_b64_tr_b16 v[104:105], v10 offset:32768
    v_mfma_f32_32x32x16_bf16 v[48:63], v[88:91], v[84:87], v[48:63]
    ds_read_b64_tr_b16 v[106:107], v10 offset:33792
    ds_read_b64_tr_b16 v[108:109], v11 offset:32768
    ds_read_b64_tr_b16 v[110:111], v11 offset:33792
    v_mfma_f32_32x32x16_bf16 v[32:47], v[92:95], v[80:83], v[32:47]
    ds_read_b128 v[112:115], v9 offset:32768
    ds_read_b128 v[116:119], v9 offset:34816
    ds_read_b64_tr_b16 v[120:121], v10 offset:36864
    v_mfma_f32_32x32x16_bf16 v[64:79], v[92:95], v[84:87], v[64:79]
    ds_read_b64_tr_b16 v[122:123], v10 offset:37888
    ds_read_b64_tr_b16 v[124:125], v11 offset:36864
    ds_read_b64_tr_b16 v[126:127], v11 offset:37888
    s_waitcnt lgkmcnt(6)
    v_mfma_f32_32x32x16_bf16 v[16:31], v[104:107], v[96:99], v[16:31]
    v_mfma_f32_32x32x16_bf16 v[48:63], v[104:107], v[100:103], v[48:63]
    v_mfma_f32_32x32x16_bf16 v[32:47], v[108:111], v[96:99], v[32:47]
    v_mfma_f32_32x32x16_bf16 v[64:79], v[108:111], v[100:103], v[64:79]
    s_waitcnt lgkmcnt(0)
    s_barrier
    v_mfma_f32_32x32x16_bf16 v[16:31], v[120:123], v[112:115], v[16:31]
    ds_read_b128 v[80:83], v12 offset:0
    ds_read_b128 v[84:87], v12 offset:2048
    ds_read_b64_tr_b16 v[88:89], v14 offset:0
    v_mfma_f32_32x32x16_bf16 v[48:63], v[120:123], v[116:119], v[48:63]
    ds_read_b64_tr_b16 v[90:91], v14 offset:1024
    ds_read_b64_tr_b16 v[92:93], v15 offset:0
    ds_read_b64_tr_b16 v[94:95], v15 offset:1024
    v_mfma_f32_32x32x16_bf16 v[32:47], v[124:127], v[112:115], v[32:47]
    ds_read_b128 v[96:99], v13 offset:0
    ds_read_b128 v[100:103], v13 offset:2048
    ds_read_b64_tr_b16 v[104:105], v14 offset:4096
    v_mfma_f32_32x32x16_bf16 v[64:79], v[124:127], v[116:119], v[64:79]
    ds_read_b64_tr_b16 v[106:107], v14 offset:5120
    ds_read_b64_tr_b16 v[108:109], v15 offset:4096
    ds_read_b64_tr_b16 v[110:111], v15 offset:5120
    s_waitcnt lgkmcnt(6)
    v_mfma_f32_32x32x16_bf16 v[16:31], v[88:91], v[80:83], v[16:31]
    v_mfma_f32_32x32x16_bf16 v[48:63], v[88:91], v[84:87], v[48:63]
    v_mfma_f32_32x32x16_bf16 v[32:47], v[92:95], v[80:83], v[32:47]
    v_mfma_f32_32x32x16_bf16 v[64:79], v[92:95], v[84:87], v[64:79]
    s_waitcnt lgkmcnt(0)
    s_barrier
    v_mfma_f32_32x32x16_bf16 v[16:31], v[104:107], v[96:99], v[16:31]
    ds_read_b128 v[112:115], v12 offset:16384
    ds_read_b128 v[116:119], v12 offset:18432
    ds_read_b64_tr_b16 v[120:121], v14 offset:16384
    v_mfma_f32_32x32x16_bf16 v[48:63], v[104:107], v[100:103], v[48:63]
    ds_read_b64_tr_b16 v[122:123], v14 offset:17408
    ds_read_b64_tr_b16 v[124:125], v15 offset:16384
    ds_read_b64_tr_b16 v[126:127], v15 offset:17408
    v_mfma_f32_32x32x16_bf16 v[32:47], v[108:111], v[96:99], v[32:47]
    ds_read_b128 v[80:83], v13 offset:16384
    ds_read_b128 v[84:87], v13 offset:18432
    ds_read_b64_tr_b16 v[88:89], v14 offset:20480
    v_mfma_f32_32x32x16_bf16 v[64:79], v[108:111], v[100:103], v[64:79]
    ds_read_b64_tr_b16 v[90:91], v14 offset:21504
    ds_read_b64_tr_b16 v[92:93], v15 offset:20480
    ds_read_b64_tr_b16 v[94:95], v15 offset:21504
    s_waitcnt lgkmcnt(6)
    v_mfma_f32_32x32x16_bf16 v[16:31], v[120:123], v[112:115], v[16:31]
    v_mfma_f32_32x32x16_bf16 v[48:63], v[120:123], v[116:119], v[48:63]
    v_mfma_f32_32x32x16_bf16 v[32:47], v[124:127], v[112:115], v[32:47]
    v_mfma_f32_32x32x16_bf16 v[64:79], v[124:127], v[116:119], v[64:79]
    s_waitcnt lgkmcnt(0)
    s_barrier
    v_mfma_f32_32x32x16_bf16 v[16:31], v[88:91], v[80:83], v[16:31]
    ds_read_b128 v[96:99], v8 offset:0
    ds_read_b128 v[100:103], v8 offset:2048
    ds_read_b64_tr_b16 v[104:105], v10 offset:0
    v_mfma_f32_32x32x16_bf16 v[48:63], v[88:91], v[84:87], v[48:63]
    ds_read_b64_tr_b16 v[106:107], v10 offset:1024
    ds_read_b64_tr_b16 v[108:109], v11 offset:0
    ds_read_b64_tr_b16 v[110:111], v11 offset:1024
    v_mfma_f32_32x32x16_bf16 v[32:47], v[92:95], v[80:83], v[32:47]
    ds_read_b128 v[112:115], v9 offset:0
    ds_read_b128 v[116:119], v9 offset:2048
    ds_read_b64_tr_b16 v[120:121], v10 offset:4096
    v_mfma_f32_32x32x16_bf16 v[64:79], v[92:95], v[84:87], v[64:79]
    ds_read_b64_tr_b16 v[122:123], v10 offset:5120
    ds_read_b64_tr_b16 v[124:125], v11 offset:4096
    ds_read_b64_tr_b16 v[126:127], v11 offset:5120
    s_waitcnt lgkmcnt(6)
    v_mfma_f32_32x32x16_bf16 v[16:31], v[104:107], v[96:99], v[16:31]
    v_mfma_f32_32x32x16_bf16 v[48:63], v[104:107], v[100:103], v[48:63]
    v_mfma_f32_32x32x16_bf16 v[32:47], v[108:111], v[96:99], v[32:47]
    v_mfma_f32_32x32x16_bf16 v[64:79], v[108:111], v[100:103], v[64:79]
    s_waitcnt lgkmcnt(0)
    s_barrier
    v_mfma_f32_32x32x16_bf16 v[16:31], v[120:123], v[112:115], v[16:31]
    ds_read_b128 v[80:83], v8 offset:16384
    ds_read_b128 v[84:87], v8 offset:18432
    ds_read_b64_tr_b16 v[88:89], v10 offset:16384
    v_mfma_f32_32x32x16_bf16 v[48:63], v[120:123], v[116:119], v[48:63]
    ds_read_b64_tr_b16 v[90:91], v10 offset:17408
    ds_read_b64_tr_b16 v[92:93], v11 offset:16384
    ds_read_b64_tr_b16 v[94:95], v11 offset:17408
    v_mfma_f32_32x32x16_bf16 v[32:47], v[124:127], v[112:115], v[32:47]
    ds_read_b128 v[96:99], v9 offset:16384
    ds_read_b128 v[100:103], v9 offset:18432
    ds_read_b64_tr_b16 v[104:105], v10 offset:20480
    v_mfma_f32_32x32x16_bf16 v[64:79], v[124:127], v[116:119], v[64:79]
    ds_read_b64_tr_b16 v[106:107], v10 offset:21504
    ds_read_b64_tr_b16 v[108:109], v11 offset:20480
    ds_read_b64_tr_b16 v[110:111], v11 offset:21504
    s_waitcnt lgkmcnt(6)
    v_mfma_f32_32x32x16_bf16 v[16:31], v[88:91], v[80:83], v[16:31]
    v_mfma_f32_32x32x16_bf16 v[48:63], v[88:91], v[84:87], v[48:63]
    v_mfma_f32_32x32x16_bf16 v[32:47], v[92:95], v[80:83], v[32:47]
    v_mfma_f32_32x32x16_bf16 v[64:79], v[92:95], v[84:87], v[64:79]
    s_waitcnt lgkmcnt(0)
    s_barrier
    v_mfma_f32_32x32x16_bf16 v[16:31], v[104:107], v[96:99], v[16:31]
    ds_read_b128 v[112:115], v8 offset:32768
    ds_read_b128 v[116:119], v8 offset:34816
    ds_read_b64_tr_b16 v[120:121], v10 offset:32768
    v_mfma_f32_32x32x16_bf16 v[48:63], v[104:107], v[100:103], v[48:63]
    ds_read_b64_tr_b16 v[122:123], v10 offset:33792
    ds_read_b64_tr_b16 v[124:125], v11 offset:32768
    ds_read_b64_tr_b16 v[126:127], v11 offset:33792
    v_mfma_f32_32x32x16_bf16 v[32:47], v[108:111], v[96:99], v[32:47]
    ds_read_b128 v[80:83], v9 offset:32768
    ds_read_b128 v[84:87], v9 offset:34816
    ds_read_b64_tr_b16 v[88:89], v10 offset:36864
    v_mfma_f32_32x32x16_bf16 v[64:79], v[108:111], v[100:103], v[64:79]
    ds_read_b64_tr_b16 v[90:91], v10 offset:37888
    ds_read_b64_tr_b16 v[92:93], v11 offset:36864
    ds_read_b64_tr_b16 v[94:95], v11 offset:37888
    s_waitcnt lgkmcnt(6)
    v_mfma_f32_32x32x16_bf16 v[16:31], v[120:123], v[112:115], v[16:31]
    v_mfma_f32_32x32x16_bf16 v[48:63], v[120:123], v[116:119], v[48:63]
    v_mfma_f32_32x32x16_bf16 v[32:47], v[124:127], v[112:115], v[32:47]
    v_mfma_f32_32x32x16_bf16 v[64:79], v[124:127], v[116:119], v[64:79]
    s_waitcnt lgkmcnt(0)
    s_barrier
    v_mfma_f32_32x32x16_bf16 v[16:31], v[88:91], v[80:83], v[16:31]
    ds_read_b128 v[96:99], v12 offset:0
    ds_read_b128 v[100:103], v12 offset:2048
    ds_read_b64_tr_b16 v[104:105], v14 offset:0
    v_mfma_f32_32x32x16_bf16 v[48:63], v[88:91], v[84:87], v[48:63]
    ds_read_b64_tr_b16 v[106:107], v14 offset:1024
    ds_read_b64_tr_b16 v[108:109], v15 offset:0
    ds_read_b64_tr_b16 v[110:111], v15 offset:1024
    v_mfma_f32_32x32x16_bf16 v[32:47], v[92:95], v[80:83], v[32:47]
    ds_read_b128 v[112:115], v13 offset:0
    ds_read_b128 v[116:119], v13 offset:2048
    ds_read_b64_tr_b16 v[120:121], v14 offset:4096
    v_mfma_f32_32x32x16_bf16 v[64:79], v[92:95], v[84:87], v[64:79]
    ds_read_b64_tr_b16 v[122:123], v14 offset:5120
    ds_read_b64_tr_b16 v[124:125], v15 offset:4096
    ds_read_b64_tr_b16 v[126:127], v15 offset:5120
    s_waitcnt lgkmcnt(6)
    v_mfma_f32_32x32x16_bf16 v[16:31], v[104:107], v[96:99], v[16:31]
    v_mfma_f32_32x32x16_bf16 v[48:63], v[104:107], v[100:103], v[48:63]
    v_mfma_f32_32x32x16_bf16 v[32:47], v[108:111], v[96:99], v[32:47]
    v_mfma_f32_32x32x16_bf16 v[64:79], v[108:111], v[100:103], v[64:79]
    s_waitcnt lgkmcnt(0)
    s_barrier
    v_mfma_f32_32x32x16_bf16 v[16:31], v[120:123], v[112:115], v[16:31]
    ds_read_b128 v[80:83], v12 offset:16384
    ds_read_b128 v[84:87], v12 offset:18432
    ds_read_b64_tr_b16 v[88:89], v14 offset:16384
    v_mfma_f32_32x32x16_bf16 v[48:63], v[120:123], v[116:119], v[48:63]
    ds_read_b64_tr_b16 v[90:91], v14 offset:17408
    ds_read_b64_tr_b16 v[92:93], v15 offset:16384
    ds_read_b64_tr_b16 v[94:95], v15 offset:17408
    v_mfma_f32_32x32x16_bf16 v[32:47], v[124:127], v[112:115], v[32:47]
    ds_read_b128 v[96:99], v13 offset:16384
    ds_read_b128 v[100:103], v13 offset:18432
    ds_read_b64_tr_b16 v[104:105], v14 offset:20480
    v_mfma_f32_32x32x16_bf16 v[64:79], v[124:127], v[116:119], v[64:79]
    ds_read_b64_tr_b16 v[106:107], v14 offset:21504
    ds_read_b64_tr_b16 v[108:109], v15 offset:20480
    ds_read_b64_tr_b16 v[110:111], v15 offset:21504
    s_waitcnt lgkmcnt(6)
    v_mfma_f32_32x32x16_bf16 v[16:31], v[88:91], v[80:83], v[16:31]
    v_mfma_f32_32x32x16_bf16 v[48:63], v[88:91], v[84:87], v[48:63]
    v_mfma_f32_32x32x16_bf16 v[32:47], v[92:95], v[80:83], v[32:47]
    v_mfma_f32_32x32x16_bf16 v[64:79], v[92:95], v[84:87], v[64:79]
    s_waitcnt lgkmcnt(0)
    s_barrier
    v_mfma_f32_32x32x16_bf16 v[16:31], v[104:107], v[96:99], v[16:31]
    ds_read_b128 v[112:115], v8 offset:0
    ds_read_b128 v[116:119], v8 offset:2048
    ds_read_b64_tr_b16 v[120:121], v10 offset:0
    v_mfma_f32_32x32x16_bf16 v[48:63], v[104:107], v[100:103], v[48:63]
    ds_read_b64_tr_b16 v[122:123], v10 offset:1024
    ds_read_b64_tr_b16 v[124:125], v11 offset:0
    ds_read_b64_tr_b16 v[126:127], v11 offset:1024
    v_mfma_f32_32x32x16_bf16 v[32:47], v[108:111], v[96:99], v[32:47]
    ds_read_b128 v[80:83], v9 offset:0
    ds_read_b128 v[84:87], v9 offset:2048
    ds_read_b64_tr_b16 v[88:89], v10 offset:4096
    v_mfma_f32_32x32x16_bf16 v[64:79], v[108:111], v[100:103], v[64:79]
    ds_read_b64_tr_b16 v[90:91], v10 offset:5120
    ds_read_b64_tr_b16 v[92:93], v11 offset:4096
    ds_read_b64_tr_b16 v[94:95], v11 offset:5120
    s_waitcnt lgkmcnt(6)
    v_mfma_f32_32x32x16_bf16 v[16:31], v[120:123], v[112:115], v[16:31]
    v_mfma_f32_32x32x16_bf16 v[48:63], v[120:123], v[116:119], v[48:63]
    v_mfma_f32_32x32x16_bf16 v[32:47], v[124:127], v[112:115], v[32:47]
    v_mfma_f32_32x32x16_bf16 v[64:79], v[124:127], v[116:119], v[64:79]
    s_waitcnt lgkmcnt(0)
    s_barrier
    v_mfma_f32_32x32x16_bf16 v[16:31], v[88:91], v[80:83], v[16:31]
    ds_read_b128 v[96:99], v8 offset:16384
    ds_read_b128 v[100:103], v8 offset:18432
    ds_read_b64_tr_b16 v[104:105], v10 offset:16384
    v_mfma_f32_32x32x16_bf16 v[48:63], v[88:91], v[84:87], v[48:63]
    ds_read_b64_tr_b16 v[106:107], v10 offset:17408
    ds_read_b64_tr_b16 v[108:109], v11 offset:16384
    ds_read_b64_tr_b16 v[110:111], v11 offset:17408
    v_mfma_f32_32x32x16_bf16 v[32:47], v[92:95], v[80:83], v[32:47]
    ds_read_b128 v[112:115], v9 offset:16384
    ds_read_b128 v[116:119], v9 offset:18432
    ds_read_b64_tr_b16 v[120:121], v10 offset:20480
    v_mfma_f32_32x32x16_bf16 v[64:79], v[92:95], v[84:87], v[64:79]
    ds_read_b64_tr_b16 v[122:123], v10 offset:21504
    ds_read_b64_tr_b16 v[124:125], v11 offset:20480
    ds_read_b64_tr_b16 v[126:127], v11 offset:21504
    s_waitcnt lgkmcnt(6)
    v_mfma_f32_32x32x16_bf16 v[16:31], v[104:107], v[96:99], v[16:31]
    v_mfma_f32_32x32x16_bf16 v[48:63], v[104:107], v[100:103], v[48:63]
    v_mfma_f32_32x32x16_bf16 v[32:47], v[108:111], v[96:99], v[32:47]
    v_mfma_f32_32x32x16_bf16 v[64:79], v[108:111], v[100:103], v[64:79]
    s_waitcnt lgkmcnt(0)
    s_barrier
    v_mfma_f32_32x32x16_bf16 v[16:31], v[120:123], v[112:115], v[16:31]
    ds_read_b128 v[80:83], v8 offset:32768
    ds_read_b128 v[84:87], v8 offset:34816
    ds_read_b64_tr_b16 v[88:89], v10 offset:32768
    v_mfma_f32_32x32x16_bf16 v[48:63], v[120:123], v[116:119], v[48:63]
    ds_read_b64_tr_b16 v[90:91], v10 offset:33792
    ds_read_b64_tr_b16 v[92:93], v11 offset:32768
    ds_read_b64_tr_b16 v[94:95], v11 offset:33792
    v_mfma_f32_32x32x16_bf16 v[32:47], v[124:127], v[112:115], v[32:47]
    ds_read_b128 v[96:99], v9 offset:32768
    ds_read_b128 v[100:103], v9 offset:34816
    ds_read_b64_tr_b16 v[104:105], v10 offset:36864
    v_mfma_f32_32x32x16_bf16 v[64:79], v[124:127], v[116:119], v[64:79]
    ds_read_b64_tr_b16 v[106:107], v10 offset:37888
    ds_read_b64_tr_b16 v[108:109], v11 offset:36864
    ds_read_b64_tr_b16 v[110:111], v11 offset:37888
    s_waitcnt lgkmcnt(6)
    v_mfma_f32_32x32x16_bf16 v[16:31], v[88:91], v[80:83], v[16:31]
    v_mfma_f32_32x32x16_bf16 v[48:63], v[88:91], v[84:87], v[48:63]
    v_mfma_f32_32x32x16_bf16 v[32:47], v[92:95], v[80:83], v[32:47]
    v_mfma_f32_32x32x16_bf16 v[64:79], v[92:95], v[84:87], v[64:79]
    s_waitcnt lgkmcnt(0)
    s_barrier
    v_mfma_f32_32x32x16_bf16 v[16:31], v[104:107], v[96:99], v[16:31]
    ds_read_b128 v[112:115], v12 offset:0
    ds_read_b128 v[116:119], v12 offset:2048
    ds_read_b64_tr_b16 v[120:121], v14 offset:0
    v_mfma_f32_32x32x16_bf16 v[48:63], v[104:107], v[100:103], v[48:63]
    ds_read_b64_tr_b16 v[122:123], v14 offset:1024
    ds_read_b64_tr_b16 v[124:125], v15 offset:0
    ds_read_b64_tr_b16 v[126:127], v15 offset:1024
    v_mfma_f32_32x32x16_bf16 v[32:47], v[108:111], v[96:99], v[32:47]
    ds_read_b128 v[80:83], v13 offset:0
    ds_read_b128 v[84:87], v13 offset:2048
    ds_read_b64_tr_b16 v[88:89], v14 offset:4096
    v_mfma_f32_32x32x16_bf16 v[64:79], v[108:111], v[100:103], v[64:79]
    ds_read_b64_tr_b16 v[90:91], v14 offset:5120
    ds_read_b64_tr_b16 v[92:93], v15 offset:4096
    ds_read_b64_tr_b16 v[94:95], v15 offset:5120
    s_waitcnt lgkmcnt(6)
    v_mfma_f32_32x32x16_bf16 v[16:31], v[120:123], v[112:115], v[16:31]
    v_mfma_f32_32x32x16_bf16 v[48:63], v[120:123], v[116:119], v[48:63]
    v_mfma_f32_32x32x16_bf16 v[32:47], v[124:127], v[112:115], v[32:47]
    v_mfma_f32_32x32x16_bf16 v[64:79], v[124:127], v[116:119], v[64:79]
    s_waitcnt lgkmcnt(0)
    s_barrier
    v_mfma_f32_32x32x16_bf16 v[16:31], v[88:91], v[80:83], v[16:31]
    ds_read_b128 v[96:99], v12 offset:16384
    ds_read_b128 v[100:103], v12 offset:18432
    ds_read_b64_tr_b16 v[104:105], v14 offset:16384
    v_mfma_f32_32x32x16_bf16 v[48:63], v[88:91], v[84:87], v[48:63]
    ds_read_b64_tr_b16 v[106:107], v14 offset:17408
    ds_read_b64_tr_b16 v[108:109], v15 offset:16384
    ds_read_b64_tr_b16 v[110:111], v15 offset:17408
    v_mfma_f32_32x32x16_bf16 v[32:47], v[92:95], v[80:83], v[32:47]
    ds_read_b128 v[112:115], v13 offset:16384
    ds_read_b128 v[116:119], v13 offset:18432
    ds_read_b64_tr_b16 v[120:121], v14 offset:20480
    v_mfma_f32_32x32x16_bf16 v[64:79], v[92:95], v[84:87], v[64:79]
    ds_read_b64_tr_b16 v[122:123], v14 offset:21504
    ds_read_b64_tr_b16 v[124:125], v15 offset:20480
    ds_read_b64_tr_b16 v[126:127], v15 offset:21504
    s_waitcnt lgkmcnt(6)
    v_mfma_f32_32x32x16_bf16 v[16:31], v[104:107], v[96:99], v[16:31]
    v_mfma_f32_32x32x16_bf16 v[48:63], v[104:107], v[100:103], v[48:63]
    v_mfma_f32_32x32x16_bf16 v[32:47], v[108:111], v[96:99], v[32:47]
    v_mfma_f32_32x32x16_bf16 v[64:79], v[108:111], v[100:103], v[64:79]
    s_waitcnt lgkmcnt(0)
    s_barrier
    v_mfma_f32_32x32x16_bf16 v[16:31], v[120:123], v[112:115], v[16:31]
    ds_read_b128 v[80:83], v8 offset:0
    ds_read_b128 v[84:87], v8 offset:2048
    ds_read_b64_tr_b16 v[88:89], v10 offset:0
    v_mfma_f32_32x32x16_bf16 v[48:63], v[120:123], v[116:119], v[48:63]
    ds_read_b64_tr_b16 v[90:91], v10 offset:1024
    ds_read_b64_tr_b16 v[92:93], v11 offset:0
    ds_read_b64_tr_b16 v[94:95], v11 offset:1024
    v_mfma_f32_32x32x16_bf16 v[32:47], v[124:127], v[112:115], v[32:47]
    ds_read_b128 v[96:99], v9 offset:0
    ds_read_b128 v[100:103], v9 offset:2048
    ds_read_b64_tr_b16 v[104:105], v10 offset:4096
    v_mfma_f32_32x32x16_bf16 v[64:79], v[124:127], v[116:119], v[64:79]
    ds_read_b64_tr_b16 v[106:107], v10 offset:5120
    ds_read_b64_tr_b16 v[108:109], v11 offset:4096
    ds_read_b64_tr_b16 v[110:111], v11 offset:5120
    s_waitcnt lgkmcnt(6)
    v_mfma_f32_32x32x16_bf16 v[16:31], v[88:91], v[80:83], v[16:31]
    v_mfma_f32_32x32x16_bf16 v[48:63], v[88:91], v[84:87], v[48:63]
    v_mfma_f32_32x32x16_bf16 v[32:47], v[92:95], v[80:83], v[32:47]
    v_mfma_f32_32x32x16_bf16 v[64:79], v[92:95], v[84:87], v[64:79]
    s_waitcnt lgkmcnt(0)
    v_mfma_f32_32x32x16_bf16 v[16:31], v[104:107], v[96:99], v[16:31]
    v_mfma_f32_32x32x16_bf16 v[48:63], v[104:107], v[100:103], v[48:63]
    v_mfma_f32_32x32x16_bf16 v[32:47], v[108:111], v[96:99], v[32:47]
    v_mfma_f32_32x32x16_bf16 v[64:79], v[108:111], v[100:103], v[64:79]
    v_and_b32 v4, 31, v1
    v_lshrrev_b32 v5, 5, v1
    v_bfe_u32 v6, v4, 1, 3
    s_lshl_b32 s24, s12, 13
    s_add_u32 s24, s24, 16384
    v_lshlrev_b32 v4, 7, v4
    v_add_u32 v4, s24, v4
    v_add_u32 v7, 0, v5
    v_xor_b32 v7, v7, v6
    v_lshl_add_u32 v8, v7, 4, v4
    v_add_u32 v7, 2, v5
    v_xor_b32 v7, v7, v6
    v_lshl_add_u32 v9, v7, 4, v4
    v_add_u32 v7, 4, v5
    v_xor_b32 v7, v7, v6
    v_lshl_add_u32 v10, v7, 4, v4
    v_add_u32 v7, 6, v5
    v_xor_b32 v7, v7, v6
    v_lshl_add_u32 v11, v7, 4, v4
    v_lshlrev_b32 v12, 4, v1
    v_add_u32 v13, s24, v12
    s_and_b32 s25, s12, 1
    s_lshl_b32 s26, s9, 1
    s_add_u32 s25, s25, s26
    s_mul_i32 s25, s25, 22
    s_lshl_b32 s26, s8, 1
    s_add_u32 s25, s25, s26
    s_lshr_b32 s26, s12, 1
    s_add_u32 s25, s25, s26
    s_lshl_b32 s25, s25, 13
    s_add_u32 s25, s25, 12582912
    v_add_u32 v12, s25, v12
    v_add_u32 v14, 4096, v12
    s_lshl_b32 s27, s8, 1
    s_add_u32 s27, s27, s26
    s_cmp_eq_u32 s27, 21
    s_cselect_b32 s28, 0, 0x7f800000
    v_max_f32 v16, 0, v16
    v_max_f32 v17, 0, v17
    v_max_f32 v18, 0, v18
    v_max_f32 v19, 0, v19
    v_max_f32 v20, 0, v20
    v_max_f32 v21, 0, v21
    v_max_f32 v22, 0, v22
    v_max_f32 v23, 0, v23
    v_max_f32 v24, 0, v24
    v_max_f32 v25, 0, v25
    v_max_f32 v26, 0, v26
    v_max_f32 v27, 0, v27
    v_max_f32 v28, 0, v28
    v_max_f32 v29, 0, v29
    v_max_f32 v30, 0, v30
    v_max_f32 v31, 0, v31
    v_cvt_pk_bf16_f32 v80, v16, v17
    v_cvt_pk_bf16_f32 v81, v18, v19
    v_cvt_pk_bf16_f32 v82, v20, v21
    v_cvt_pk_bf16_f32 v83, v22, v23
    v_cvt_pk_bf16_f32 v84, v24, v25
    v_cvt_pk_bf16_f32 v85, v26, v27
    v_cvt_pk_bf16_f32 v86, v28, v29
    v_cvt_pk_bf16_f32 v87, v30, v31
    v_permlane32_swap_b32 v80, v82
    v_permlane32_swap_b32 v81, v83
    v_permlane32_swap_b32 v84, v86
    v_permlane32_swap_b32 v85, v87
    ds_write_b128 v8, v[80:83] offset:0
    ds_write_b128 v9, v[84:87] offset:0
    v_med3_f32 v32, 0, v32, s28
    v_med3_f32 v33, 0, v33, s28
    v_med3_f32 v34, 0, v34, s28
    v_med3_f32 v35, 0, v35, s28
    v_med3_f32 v36, 0, v36, s28
    v_med3_f32 v37, 0, v37, s28
    v_med3_f32 v38, 0, v38, s28
    v_med3_f32 v39, 0, v39, s28
    v_med3_f32 v40, 0, v40, s28
    v_med3_f32 v41, 0, v41, s28
    v_med3_f32 v42, 0, v42, s28
    v_med3_f32 v43, 0, v43, s28
    v_med3_f32 v44, 0, v44, s28
    v_med3_f32 v45, 0, v45, s28
    v_med3_f32 v46, 0, v46, s28
    v_med3_f32 v47, 0, v47, s28
    v_cvt_pk_bf16_f32 v96, v32, v33
    v_cvt_pk_bf16_f32 v97, v34, v35
    v_cvt_pk_bf16_f32 v98, v36, v37
    v_cvt_pk_bf16_f32 v99, v38, v39
    v_cvt_pk_bf16_f32 v100, v40, v41
    v_cvt_pk_bf16_f32 v101, v42, v43
    v_cvt_pk_bf16_f32 v102, v44, v45
    v_cvt_pk_bf16_f32 v103, v46, v47
    v_permlane32_swap_b32 v96, v98
    v_permlane32_swap_b32 v97, v99
    v_permlane32_swap_b32 v100, v102
    v_permlane32_swap_b32 v101, v103
    ds_write_b128 v10, v[96:99] offset:0
    ds_write_b128 v11, v[100:103] offset:0
    s_waitcnt lgkmcnt(0)
    ds_read_b128 v[16:19], v13 offset:0
    ds_read_b128 v[20:23], v13 offset:1024
    ds_read_b128 v[24:27], v13 offset:2048
    ds_read_b128 v[28:31], v13 offset:3072
    s_waitcnt lgkmcnt(3)
    global_store_dwordx4 v12, v[16:19], s[6:7] offset:0 sc1
    s_waitcnt lgkmcnt(2)
    global_store_dwordx4 v12, v[20:23], s[6:7] offset:1024 sc1
    s_waitcnt lgkmcnt(1)
    global_store_dwordx4 v12, v[24:27], s[6:7] offset:2048 sc1
    s_waitcnt lgkmcnt(0)
    global_store_dwordx4 v12, v[28:31], s[6:7] offset:3072 sc1
    v_max_f32 v48, 0, v48
    v_max_f32 v49, 0, v49
    v_max_f32 v50, 0, v50
    v_max_f32 v51, 0, v51
    v_max_f32 v52, 0, v52
    v_max_f32 v53, 0, v53
    v_max_f32 v54, 0, v54
    v_max_f32 v55, 0, v55
    v_max_f32 v56, 0, v56
    v_max_f32 v57, 0, v57
    v_max_f32 v58, 0, v58
    v_max_f32 v59, 0, v59
    v_max_f32 v60, 0, v60
    v_max_f32 v61, 0, v61
    v_max_f32 v62, 0, v62
    v_max_f32 v63, 0, v63
    v_cvt_pk_bf16_f32 v88, v48, v49
    v_cvt_pk_bf16_f32 v89, v50, v51
    v_cvt_pk_bf16_f32 v90, v52, v53
    v_cvt_pk_bf16_f32 v91, v54, v55
    v_cvt_pk_bf16_f32 v92, v56, v57
    v_cvt_pk_bf16_f32 v93, v58, v59
    v_cvt_pk_bf16_f32 v94, v60, v61
    v_cvt_pk_bf16_f32 v95, v62, v63
    v_permlane32_swap_b32 v88, v90
    v_permlane32_swap_b32 v89, v91
    v_permlane32_swap_b32 v92, v94
    v_permlane32_swap_b32 v93, v95
    ds_write_b128 v8, v[88:91] offset:4096
    ds_write_b128 v9, v[92:95] offset:4096
    v_med3_f32 v64, 0, v64, s28
    v_med3_f32 v65, 0, v65, s28
    v_med3_f32 v66, 0, v66, s28
    v_med3_f32 v67, 0, v67, s28
    v_med3_f32 v68, 0, v68, s28
    v_med3_f32 v69, 0, v69, s28
    v_med3_f32 v70, 0, v70, s28
    v_med3_f32 v71, 0, v71, s28
    v_med3_f32 v72, 0, v72, s28
    v_med3_f32 v73, 0, v73, s28
    v_med3_f32 v74, 0, v74, s28
    v_med3_f32 v75, 0, v75, s28
    v_med3_f32 v76, 0, v76, s28
    v_med3_f32 v77, 0, v77, s28
    v_med3_f32 v78, 0, v78, s28
    v_med3_f32 v79, 0, v79, s28
    v_cvt_pk_bf16_f32 v104, v64, v65
    v_cvt_pk_bf16_f32 v105, v66, v67
    v_cvt_pk_bf16_f32 v106, v68, v69
    v_cvt_pk_bf16_f32 v107, v70, v71
    v_cvt_pk_bf16_f32 v108, v72, v73
    v_cvt_pk_bf16_f32 v109, v74, v75
    v_cvt_pk_bf16_f32 v110, v76, v77
    v_cvt_pk_bf16_f32 v111, v78, v79
    v_permlane32_swap_b32 v104, v106
    v_permlane32_swap_b32 v105, v107
    v_permlane32_swap_b32 v108, v110
    v_permlane32_swap_b32 v109, v111
    ds_write_b128 v10, v[104:107] offset:4096
    ds_write_b128 v11, v[108:111] offset:4096
    s_waitcnt lgkmcnt(0)
    ds_read_b128 v[48:51], v13 offset:4096
    ds_read_b128 v[52:55], v13 offset:5120
    ds_read_b128 v[56:59], v13 offset:6144
    ds_read_b128 v[60:63], v13 offset:7168
    s_waitcnt lgkmcnt(3)
    global_store_dwordx4 v14, v[48:51], s[6:7] offset:0 sc1
    s_waitcnt lgkmcnt(2)
    global_store_dwordx4 v14, v[52:55], s[6:7] offset:1024 sc1
    s_waitcnt lgkmcnt(1)
    global_store_dwordx4 v14, v[56:59], s[6:7] offset:2048 sc1
    s_waitcnt lgkmcnt(0)
    global_store_dwordx4 v14, v[60:63], s[6:7] offset:3072 sc1
L_g1_done:
    s_endpgm
L_k2_conv:
    s_nop 3
    s_sub_u32 s28, s2, 176
    s_load_dwordx2 s[4:5], s[0:1], 64
    s_load_dwordx2 s[6:7], s[0:1], 112
    v_lshrrev_b32 v10, 8, v0
    s_nop 0
    v_readfirstlane_b32 s27, v10
    v_and_b32 v10, 255, v0
    v_and_b32 v1, 63, v0
    v_lshrrev_b32 v2, 6, v10
    v_and_b32 v3, 15, v1
    v_lshrrev_b32 v4, 4, v1
    s_and_b32 s26, s28, 7
    s_lshr_b32 s28, s28, 3
    s_mov_b32 s30, s28
    s_load_dwordx2 s[32:33], s[0:1], 88
    s_lshl_b32 s25, s28, 1
    s_add_u32 s25, s25, s27
    s_mov_b32 s31, 0
    s_cmp_lt_u32 s28, 10
    s_cbranch_scc1 L_cv_q
    s_sub_u32 s25, s25, 20
    s_cmp_ge_u32 s28, 32
    s_cbranch_scc1 L_cv_q
    s_add_u32 s25, s28, 10
    s_cmp_eq_u32 s27, 0
    s_cbranch_scc1 L_cv_q
    s_cmp_ge_u32 s28, 14
    s_cbranch_scc1 L_k2_exit
    s_sub_u32 s25, s28, 10
    s_and_b32 s31, s25, 1
    s_add_u32 s31, s31, 1
    s_lshr_b32 s25, s25, 1
    s_add_u32 s25, s25, 42
L_cv_q:
    s_lshl_b32 s28, s25, 3
    s_add_u32 s28, s28, s26
    s_mul_i32 s29, s27, 40960
    s_lshl_b32 s3, s28, 12
    s_add_u32 s8, s3, 2097152
    s_mul_i32 s9, s28, 4096
    s_add_u32 s9, s9, 4194304
    v_lshlrev_b32 v5, 4, v10
    v_add_u32 v6, s8, v5
    v_add_u32 v7, s9, v5
    s_lshl_b32 s10, s28, 1
    v_mov_b32 v8, s10
    s_waitcnt lgkmcnt(0)
    v_subrev_u32 v11, 4, v5
    v_max_i32 v11, 0, v11
    v_add_u32 v11, s9, v11
    global_load_dwordx4 v[48:51], v6, s[6:7]
    global_load_dwordx4 v[52:55], v7, s[6:7]
    global_load_dword v56, v11, s[6:7]
    global_load_ushort v9, v8, s[4:5]
    v_add_u32 v5, s29, v5
    v_mov_b32 v64, 0
    v_mov_b32 v65, 0
    v_mov_b32 v66, 0
    v_mov_b32 v67, 0
    v_and_b32 v7, 31, v10
    v_lshlrev_b32 v7, 4, v7
    v_add_u32 v7, s29, v7
    ds_write_b128 v7, v[64:67]
    v_and_b32 v7, 15, v10
    v_min_u32 v11, 14, v7
    v_lshlrev_b32 v11, 2, v11
    v_add_u32 v11, s29, v11
    ds_write_b32 v11, v64 offset:8708
    v_lshlrev_b32 v7, 2, v7
    v_add_u32 v7, 12864, v7
    v_mov_b32 v11, 8704
    s_movk_i32 s14, 255
    v_cmp_eq_u32 vcc, s14, v10
    s_nop 1
    v_cndmask_b32 v68, v7, v11, vcc
    v_add_u32 v68, s29, v68
    v_cndmask_b32 v69, 0, 1, vcc
    v_lshrrev_b32 v7, 1, v4
    v_and_b32 v11, 1, v4
    v_sub_u32 v6, v3, v7
    v_lshlrev_b32 v6, 5, v6
    v_lshl_add_u32 v6, v11, 4, v6
    v_lshlrev_b32 v16, 6, v2
    v_sub_u32 v6, v6, v16
    v_add_u32 v6, 256, v6
    v_add_u32 v6, s29, v6
    v_and_b32 v16, 1, v3
    v_lshlrev_b32 v12, 5, v2
    v_lshl_add_u32 v12, v7, 4, v12
    v_add_u32 v12, v12, v3
    v_add_u32 v12, v12, v16
    v_lshlrev_b32 v13, 3, v11
    v_sub_u32 v12, v13, v12
    v_add_u32 v12, 1664, v12
    v_lshlrev_b32 v12, 1, v12
    v_mul_u32_u24 v16, 4160, v16
    v_add_u32 v12, v12, v16
    v_add_u32 v12, 4608, v12
    v_add_u32 v12, s29, v12
    v_subrev_u32 v13, 1024, v12
    v_subrev_u32 v14, 2048, v12
    v_subrev_u32 v15, 3072, v12
    s_waitcnt vmcnt(3)
    ds_write_b128 v5, v[48:51] offset:512
    s_waitcnt vmcnt(1)
    ds_write_b128 v5, v[52:55] offset:8768
    v_cmp_eq_u32 vcc, 0, v10
    s_nop 1
    v_cndmask_b32 v56, v56, 0, vcc
    v_alignbit_b32 v60, v52, v56, 16
    v_alignbit_b32 v61, v53, v52, 16
    v_alignbit_b32 v62, v54, v53, 16
    v_alignbit_b32 v63, v55, v54, 16
    ds_write_b128 v5, v[60:63] offset:4608
    v_lshrrev_b32 v57, 16, v55
    v_mul_u32_u24 v57, v57, v69
    ds_write_b32 v68, v57
    s_waitcnt vmcnt(0) lgkmcnt(0)
    s_barrier
    s_cmp_eq_u32 s31, 0
    s_cbranch_scc1 L_cv_full
    s_cmp_eq_u32 s31, 1
    s_cbranch_scc1 L_cv_even
    ds_read_b128 v[48:51], v6 offset:0
    ds_read_b128 v[52:55], v6 offset:256
    ds_read_b128 v[56:59], v6 offset:512
    ds_read_b128 v[60:63], v6 offset:768
    ds_read_b128 v[64:67], v6 offset:1024
    ds_read_b128 v[68:71], v6 offset:1280
    ds_read_b128 v[72:75], v6 offset:1536
    ds_read_b128 v[76:79], v6 offset:1792
    ds_read_b128 v[80:83], v6 offset:2048
    ds_read_b128 v[84:87], v6 offset:2304
    ds_read_b128 v[88:91], v6 offset:2560
    ds_read_b128 v[92:95], v6 offset:2816
    ds_read_b128 v[96:99], v6 offset:3072
    ds_read_b128 v[100:103], v6 offset:3328
    ds_read_b128 v[104:107], v6 offset:3584
    ds_read_b128 v[108:111], v6 offset:3840
    v_mov_b32 v16, 0
    v_mov_b32 v17, 0
    v_mov_b32 v18, 0
    v_mov_b32 v19, 0
    v_mov_b32 v20, 0
    v_mov_b32 v21, 0
    v_mov_b32 v22, 0
    v_mov_b32 v23, 0
    v_mov_b32 v24, 0
    v_mov_b32 v25, 0
    v_mov_b32 v26, 0
    v_mov_b32 v27, 0
    v_mov_b32 v28, 0
    v_mov_b32 v29, 0
    v_mov_b32 v30, 0
    v_mov_b32 v31, 0
    v_mov_b32 v32, 0
    v_mov_b32 v33, 0
    v_mov_b32 v34, 0
    v_mov_b32 v35, 0
    v_mov_b32 v36, 0
    v_mov_b32 v37, 0
    v_mov_b32 v38, 0
    v_mov_b32 v39, 0
    v_mov_b32 v40, 0
    v_mov_b32 v41, 0
    v_mov_b32 v42, 0
    v_mov_b32 v43, 0
    v_mov_b32 v44, 0
    v_mov_b32 v45, 0
    v_mov_b32 v46, 0
    v_mov_b32 v47, 0
    ds_read2_b32 v[112:113], v12 offset0:192 offset1:193
    ds_read2_b32 v[114:115], v12 offset0:194 offset1:195
    ds_read2_b32 v[116:117], v12 offset0:128 offset1:129
    ds_read2_b32 v[118:119], v12 offset0:130 offset1:131
    ds_read2_b32 v[120:121], v12 offset0:64 offset1:65
    ds_read2_b32 v[122:123], v12 offset0:66 offset1:67
    s_waitcnt lgkmcnt(4)
    v_mfma_f32_16x16x32_bf16 v[20:23], v[112:115], v[60:63], v[20:23]
    ds_read2_b32 v[124:125], v12 offset0:0 offset1:1
    ds_read2_b32 v[126:127], v12 offset0:2 offset1:3
    v_mfma_f32_16x16x32_bf16 v[28:31], v[112:115], v[76:79], v[28:31]
    v_mfma_f32_16x16x32_bf16 v[36:39], v[112:115], v[92:95], v[36:39]
    v_mfma_f32_16x16x32_bf16 v[44:47], v[112:115], v[108:111], v[44:47]
    s_waitcnt lgkmcnt(4)
    v_mfma_f32_16x16x32_bf16 v[20:23], v[116:119], v[56:59], v[20:23]
    ds_read2_b32 v[112:113], v13 offset0:192 offset1:193
    ds_read2_b32 v[114:115], v13 offset0:194 offset1:195
    v_mfma_f32_16x16x32_bf16 v[28:31], v[116:119], v[72:75], v[28:31]
    v_mfma_f32_16x16x32_bf16 v[36:39], v[116:119], v[88:91], v[36:39]
    v_mfma_f32_16x16x32_bf16 v[44:47], v[116:119], v[104:107], v[44:47]
    s_waitcnt lgkmcnt(4)
    v_mfma_f32_16x16x32_bf16 v[20:23], v[120:123], v[52:55], v[20:23]
    ds_read2_b32 v[116:117], v13 offset0:128 offset1:129
    ds_read2_b32 v[118:119], v13 offset0:130 offset1:131
    v_mfma_f32_16x16x32_bf16 v[28:31], v[120:123], v[68:71], v[28:31]
    v_mfma_f32_16x16x32_bf16 v[36:39], v[120:123], v[84:87], v[36:39]
    v_mfma_f32_16x16x32_bf16 v[44:47], v[120:123], v[100:103], v[44:47]
    s_waitcnt lgkmcnt(4)
    v_mfma_f32_16x16x32_bf16 v[20:23], v[124:127], v[48:51], v[20:23]
    ds_read2_b32 v[120:121], v13 offset0:64 offset1:65
    ds_read2_b32 v[122:123], v13 offset0:66 offset1:67
    v_mfma_f32_16x16x32_bf16 v[28:31], v[124:127], v[64:67], v[28:31]
    v_mfma_f32_16x16x32_bf16 v[36:39], v[124:127], v[80:83], v[36:39]
    v_mfma_f32_16x16x32_bf16 v[44:47], v[124:127], v[96:99], v[44:47]
    s_waitcnt lgkmcnt(4)
    v_mfma_f32_16x16x32_bf16 v[28:31], v[112:115], v[60:63], v[28:31]
    ds_read2_b32 v[124:125], v13 offset0:0 offset1:1
    ds_read2_b32 v[126:127], v13 offset0:2 offset1:3
    v_mfma_f32_16x16x32_bf16 v[36:39], v[112:115], v[76:79], v[36:39]
    v_mfma_f32_16x16x32_bf16 v[44:47], v[112:115], v[92:95], v[44:47]
    s_waitcnt lgkmcnt(4)
    v_mfma_f32_16x16x32_bf16 v[28:31], v[116:119], v[56:59], v[28:31]
    ds_read2_b32 v[112:113], v14 offset0:192 offset1:193
    ds_read2_b32 v[114:115], v14 offset0:194 offset1:195
    v_mfma_f32_16x16x32_bf16 v[36:39], v[116:119], v[72:75], v[36:39]
    v_mfma_f32_16x16x32_bf16 v[44:47], v[116:119], v[88:91], v[44:47]
    s_waitcnt lgkmcnt(4)
    v_mfma_f32_16x16x32_bf16 v[28:31], v[120:123], v[52:55], v[28:31]
    ds_read2_b32 v[116:117], v14 offset0:128 offset1:129
    ds_read2_b32 v[118:119], v14 offset0:130 offset1:131
    v_mfma_f32_16x16x32_bf16 v[36:39], v[120:123], v[68:71], v[36:39]
    v_mfma_f32_16x16x32_bf16 v[44:47], v[120:123], v[84:87], v[44:47]
    s_waitcnt lgkmcnt(4)
    v_mfma_f32_16x16x32_bf16 v[28:31], v[124:127], v[48:51], v[28:31]
    ds_read2_b32 v[120:121], v14 offset0:64 offset1:65
    ds_read2_b32 v[122:123], v14 offset0:66 offset1:67
    v_mfma_f32_16x16x32_bf16 v[36:39], v[124:127], v[64:67], v[36:39]
    v_mfma_f32_16x16x32_bf16 v[44:47], v[124:127], v[80:83], v[44:47]
    s_waitcnt lgkmcnt(4)
    v_mfma_f32_16x16x32_bf16 v[36:39], v[112:115], v[60:63], v[36:39]
    ds_read2_b32 v[124:125], v14 offset0:0 offset1:1
    ds_read2_b32 v[126:127], v14 offset0:2 offset1:3
    v_mfma_f32_16x16x32_bf16 v[44:47], v[112:115], v[76:79], v[44:47]
    s_waitcnt lgkmcnt(4)
    v_mfma_f32_16x16x32_bf16 v[36:39], v[116:119], v[56:59], v[36:39]
    ds_read2_b32 v[112:113], v15 offset0:192 offset1:193
    ds_read2_b32 v[114:115], v15 offset0:194 offset1:195
    v_mfma_f32_16x16x32_bf16 v[44:47], v[116:119], v[72:75], v[44:47]
    s_waitcnt lgkmcnt(4)
    v_mfma_f32_16x16x32_bf16 v[36:39], v[120:123], v[52:55], v[36:39]
    ds_read2_b32 v[116:117], v15 offset0:128 offset1:129
    ds_read2_b32 v[118:119], v15 offset0:130 offset1:131
    v_mfma_f32_16x16x32_bf16 v[44:47], v[120:123], v[68:71], v[44:47]
    s_waitcnt lgkmcnt(4)
    v_mfma_f32_16x16x32_bf16 v[36:39], v[124:127], v[48:51], v[36:39]
    ds_read2_b32 v[120:121], v15 offset0:64 offset1:65
    ds_read2_b32 v[122:123], v15 offset0:66 offset1:67
    v_mfma_f32_16x16x32_bf16 v[44:47], v[124:127], v[64:67], v[44:47]
    s_waitcnt lgkmcnt(4)
    v_mfma_f32_16x16x32_bf16 v[44:47], v[112:115], v[60:63], v[44:47]
    ds_read2_b32 v[124:125], v15 offset0:0 offset1:1
    ds_read2_b32 v[126:127], v15 offset0:2 offset1:3
    s_waitcnt lgkmcnt(4)
    v_mfma_f32_16x16x32_bf16 v[44:47], v[116:119], v[56:59], v[44:47]
    s_waitcnt lgkmcnt(2)
    v_mfma_f32_16x16x32_bf16 v[44:47], v[120:123], v[52:55], v[44:47]
    s_waitcnt lgkmcnt(0)
    v_mfma_f32_16x16x32_bf16 v[44:47], v[124:127], v[48:51], v[44:47]
    v_lshlrev_b32 v5, 13, v2
    v_lshl_add_u32 v5, v1, 4, v5
    v_add_u32 v5, s29, v5
    s_barrier
    ds_write_b128 v5, v[20:23] offset:9216
    ds_write_b128 v5, v[28:31] offset:11264
    ds_write_b128 v5, v[36:39] offset:13312
    s_nop 0
    ds_write_b128 v5, v[44:47] offset:15360
    v_lshlrev_b32 v5, 11, v2
    v_lshl_add_u32 v5, v1, 4, v5
    v_add_u32 v5, s29, v5
    v_lshlrev_b32 v6, 9, v2
    v_lshl_add_u32 v6, v3, 4, v6
    v_lshl_add_u32 v6, v4, 2, v6
    v_lshlrev_b32 v6, 1, v6
    v_add_u32 v7, s29, v6
    s_waitcnt lgkmcnt(0)
    s_barrier
    ds_read_b128 v[64:67], v5 offset:9216
    ds_read_b128 v[68:71], v5 offset:17408
    ds_read_b128 v[72:75], v5 offset:25600
    ds_read_b128 v[76:79], v5 offset:33792
    ds_read_b64 v[82:83], v7 offset:1024
    v_lshlrev_b32 v9, 16, v9
    s_add_u32 s3, s3, 9437184
    v_add_u32 v6, s3, v6
    s_waitcnt lgkmcnt(0)
    v_add_f32 v64, v64, v68
    v_add_f32 v72, v72, v76
    v_add_f32 v65, v65, v69
    v_add_f32 v73, v73, v77
    v_add_f32 v66, v66, v70
    v_add_f32 v74, v74, v78
    v_add_f32 v67, v67, v71
    v_add_f32 v75, v75, v79
    v_add_f32 v64, v64, v72
    v_add_f32 v65, v65, v73
    v_add_f32 v66, v66, v74
    v_add_f32 v67, v67, v75
    v_cvt_pk_bf16_f32 v68, v64, v65
    v_cvt_pk_bf16_f32 v69, v66, v67
    v_lshlrev_b32 v72, 16, v82
    v_and_b32 v73, 0xffff0000, v82
    v_lshlrev_b32 v74, 16, v83
    v_and_b32 v75, 0xffff0000, v83
    v_mul_f32 v72, v9, v72
    v_mul_f32 v73, v9, v73
    v_mul_f32 v74, v9, v74
    v_mul_f32 v75, v9, v75
    v_cvt_pk_bf16_f32 v70, v72, v73
    v_cvt_pk_bf16_f32 v71, v74, v75
    v_lshlrev_b32 v64, 16, v68
    v_and_b32 v65, 0xffff0000, v68
    v_lshlrev_b32 v66, 16, v69
    v_and_b32 v67, 0xffff0000, v69
    v_lshlrev_b32 v72, 16, v70
    v_and_b32 v73, 0xffff0000, v70
    v_lshlrev_b32 v74, 16, v71
    v_and_b32 v75, 0xffff0000, v71
    v_add_f32 v64, v64, v72
    v_add_f32 v65, v65, v73
    v_add_f32 v66, v66, v74
    v_add_f32 v67, v67, v75
    v_cvt_pk_bf16_f32 v68, v64, v65
    v_cvt_pk_bf16_f32 v69, v66, v67
    global_store_dwordx2 v6, v[68:69], s[6:7] offset:512 sc1
    s_endpgm
L_cv_even:
    s_nop 3
    ds_read_b128 v[48:51], v6 offset:0
    ds_read_b128 v[52:55], v6 offset:256
    ds_read_b128 v[56:59], v6 offset:512
    ds_read_b128 v[60:63], v6 offset:768
    ds_read_b128 v[64:67], v6 offset:1024
    ds_read_b128 v[68:71], v6 offset:1280
    ds_read_b128 v[72:75], v6 offset:1536
    ds_read_b128 v[76:79], v6 offset:1792
    ds_read_b128 v[80:83], v6 offset:2048
    ds_read_b128 v[84:87], v6 offset:2304
    ds_read_b128 v[88:91], v6 offset:2560
    ds_read_b128 v[92:95], v6 offset:2816
    ds_read_b128 v[96:99], v6 offset:3072
    ds_read_b128 v[100:103], v6 offset:3328
    v_mov_b32 v16, 0
    v_mov_b32 v17, 0
    v_mov_b32 v18, 0
    v_mov_b32 v19, 0
    v_mov_b32 v20, 0
    v_mov_b32 v21, 0
    v_mov_b32 v22, 0
    v_mov_b32 v23, 0
    v_mov_b32 v24, 0
    v_mov_b32 v25, 0
    v_mov_b32 v26, 0
    v_mov_b32 v27, 0
    v_mov_b32 v28, 0
    v_mov_b32 v29, 0
    v_mov_b32 v30, 0
    v_mov_b32 v31, 0
    v_mov_b32 v32, 0
    v_mov_b32 v33, 0
    v_mov_b32 v34, 0
    v_mov_b32 v35, 0
    v_mov_b32 v36, 0
    v_mov_b32 v37, 0
    v_mov_b32 v38, 0
    v_mov_b32 v39, 0
    v_mov_b32 v40, 0
    v_mov_b32 v41, 0
    v_mov_b32 v42, 0
    v_mov_b32 v43, 0
    v_mov_b32 v44, 0
    v_mov_b32 v45, 0
    v_mov_b32 v46, 0
    v_mov_b32 v47, 0
    ds_read2_b32 v[112:113], v12 offset0:192 offset1:193
    ds_read2_b32 v[114:115], v12 offset0:194 offset1:195
    ds_read2_b32 v[116:117], v12 offset0:128 offset1:129
    ds_read2_b32 v[118:119], v12 offset0:130 offset1:131
    ds_read2_b32 v[120:121], v12 offset0:64 offset1:65
    ds_read2_b32 v[122:123], v12 offset0:66 offset1:67
    s_waitcnt lgkmcnt(4)
    v_mfma_f32_16x16x32_bf16 v[16:19], v[112:115], v[52:55], v[16:19]
    ds_read2_b32 v[124:125], v12 offset0:0 offset1:1
    ds_read2_b32 v[126:127], v12 offset0:2 offset1:3
    v_mfma_f32_16x16x32_bf16 v[24:27], v[112:115], v[68:71], v[24:27]
    v_mfma_f32_16x16x32_bf16 v[32:35], v[112:115], v[84:87], v[32:35]
    v_mfma_f32_16x16x32_bf16 v[40:43], v[112:115], v[100:103], v[40:43]
    s_waitcnt lgkmcnt(4)
    v_mfma_f32_16x16x32_bf16 v[16:19], v[116:119], v[48:51], v[16:19]
    ds_read2_b32 v[112:113], v13 offset0:192 offset1:193
    ds_read2_b32 v[114:115], v13 offset0:194 offset1:195
    v_mfma_f32_16x16x32_bf16 v[24:27], v[116:119], v[64:67], v[24:27]
    v_mfma_f32_16x16x32_bf16 v[32:35], v[116:119], v[80:83], v[32:35]
    v_mfma_f32_16x16x32_bf16 v[40:43], v[116:119], v[96:99], v[40:43]
    s_waitcnt lgkmcnt(4)
    v_mfma_f32_16x16x32_bf16 v[24:27], v[120:123], v[60:63], v[24:27]
    ds_read2_b32 v[116:117], v13 offset0:128 offset1:129
    ds_read2_b32 v[118:119], v13 offset0:130 offset1:131
    v_mfma_f32_16x16x32_bf16 v[32:35], v[120:123], v[76:79], v[32:35]
    v_mfma_f32_16x16x32_bf16 v[40:43], v[120:123], v[92:95], v[40:43]
    s_waitcnt lgkmcnt(4)
    v_mfma_f32_16x16x32_bf16 v[24:27], v[124:127], v[56:59], v[24:27]
    ds_read2_b32 v[120:121], v13 offset0:64 offset1:65
    ds_read2_b32 v[122:123], v13 offset0:66 offset1:67
    v_mfma_f32_16x16x32_bf16 v[32:35], v[124:127], v[72:75], v[32:35]
    v_mfma_f32_16x16x32_bf16 v[40:43], v[124:127], v[88:91], v[40:43]
    s_waitcnt lgkmcnt(4)
    v_mfma_f32_16x16x32_bf16 v[24:27], v[112:115], v[52:55], v[24:27]
    ds_read2_b32 v[124:125], v13 offset0:0 offset1:1
    ds_read2_b32 v[126:127], v13 offset0:2 offset1:3
    v_mfma_f32_16x16x32_bf16 v[32:35], v[112:115], v[68:71], v[32:35]
    v_mfma_f32_16x16x32_bf16 v[40:43], v[112:115], v[84:87], v[40:43]
    s_waitcnt lgkmcnt(4)
    v_mfma_f32_16x16x32_bf16 v[24:27], v[116:119], v[48:51], v[24:27]
    ds_read2_b32 v[112:113], v14 offset0:192 offset1:193
    ds_read2_b32 v[114:115], v14 offset0:194 offset1:195
    v_mfma_f32_16x16x32_bf16 v[32:35], v[116:119], v[64:67], v[32:35]
    v_mfma_f32_16x16x32_bf16 v[40:43], v[116:119], v[80:83], v[40:43]
    s_waitcnt lgkmcnt(4)
    v_mfma_f32_16x16x32_bf16 v[32:35], v[120:123], v[60:63], v[32:35]
    ds_read2_b32 v[116:117], v14 offset0:128 offset1:129
    ds_read2_b32 v[118:119], v14 offset0:130 offset1:131
    v_mfma_f32_16x16x32_bf16 v[40:43], v[120:123], v[76:79], v[40:43]
    s_waitcnt lgkmcnt(4)
    v_mfma_f32_16x16x32_bf16 v[32:35], v[124:127], v[56:59], v[32:35]
    ds_read2_b32 v[120:121], v14 offset0:64 offset1:65
    ds_read2_b32 v[122:123], v14 offset0:66 offset1:67
    v_mfma_f32_16x16x32_bf16 v[40:43], v[124:127], v[72:75], v[40:43]
    s_waitcnt lgkmcnt(4)
    v_mfma_f32_16x16x32_bf16 v[32:35], v[112:115], v[52:55], v[32:35]
    ds_read2_b32 v[124:125], v14 offset0:0 offset1:1
    ds_read2_b32 v[126:127], v14 offset0:2 offset1:3
    v_mfma_f32_16x16x32_bf16 v[40:43], v[112:115], v[68:71], v[40:43]
    s_waitcnt lgkmcnt(4)
    v_mfma_f32_16x16x32_bf16 v[32:35], v[116:119], v[48:51], v[32:35]
    ds_read2_b32 v[112:113], v15 offset0:192 offset1:193
    ds_read2_b32 v[114:115], v15 offset0:194 offset1:195
    v_mfma_f32_16x16x32_bf16 v[40:43], v[116:119], v[64:67], v[40:43]
    s_waitcnt lgkmcnt(4)
    v_mfma_f32_16x16x32_bf16 v[40:43], v[120:123], v[60:63], v[40:43]
    ds_read2_b32 v[116:117], v15 offset0:128 offset1:129
    ds_read2_b32 v[118:119], v15 offset0:130 offset1:131
    s_waitcnt lgkmcnt(4)
    v_mfma_f32_16x16x32_bf16 v[40:43], v[124:127], v[56:59], v[40:43]
    s_waitcnt lgkmcnt(2)
    v_mfma_f32_16x16x32_bf16 v[40:43], v[112:115], v[52:55], v[40:43]
    s_waitcnt lgkmcnt(0)
    v_mfma_f32_16x16x32_bf16 v[40:43], v[116:119], v[48:51], v[40:43]
    v_lshlrev_b32 v5, 13, v2
    v_lshl_add_u32 v5, v1, 4, v5
    v_add_u32 v5, s29, v5
    s_barrier
    ds_write_b128 v5, v[16:19] offset:8192
    ds_write_b128 v5, v[24:27] offset:10240
    ds_write_b128 v5, v[32:35] offset:12288
    s_nop 0
    ds_write_b128 v5, v[40:43] offset:14336
    v_lshlrev_b32 v5, 11, v2
    v_lshl_add_u32 v5, v1, 4, v5
    v_add_u32 v5, s29, v5
    v_lshlrev_b32 v6, 9, v2
    v_lshl_add_u32 v6, v3, 4, v6
    v_lshl_add_u32 v6, v4, 2, v6
    v_lshlrev_b32 v6, 1, v6
    v_add_u32 v7, s29, v6
    s_waitcnt lgkmcnt(0)
    s_barrier
    ds_read_b128 v[48:51], v5 offset:8192
    ds_read_b128 v[52:55], v5 offset:16384
    ds_read_b128 v[56:59], v5 offset:24576
    ds_read_b128 v[60:63], v5 offset:32768
    ds_read_b64 v[80:81], v7 offset:512
    v_lshlrev_b32 v9, 16, v9
    s_add_u32 s3, s3, 9437184
    v_add_u32 v6, s3, v6
    s_waitcnt lgkmcnt(0)
    v_add_f32 v48, v48, v52
    v_add_f32 v56, v56, v60
    v_add_f32 v49, v49, v53
    v_add_f32 v57, v57, v61
    v_add_f32 v50, v50, v54
    v_add_f32 v58, v58, v62
    v_add_f32 v51, v51, v55
    v_add_f32 v59, v59, v63
    v_add_f32 v48, v48, v56
    v_add_f32 v49, v49, v57
    v_add_f32 v50, v50, v58
    v_add_f32 v51, v51, v59
    v_cvt_pk_bf16_f32 v52, v48, v49
    v_cvt_pk_bf16_f32 v53, v50, v51
    v_lshlrev_b32 v56, 16, v80
    v_and_b32 v57, 0xffff0000, v80
    v_lshlrev_b32 v58, 16, v81
    v_and_b32 v59, 0xffff0000, v81
    v_mul_f32 v56, v9, v56
    v_mul_f32 v57, v9, v57
    v_mul_f32 v58, v9, v58
    v_mul_f32 v59, v9, v59
    v_cvt_pk_bf16_f32 v54, v56, v57
    v_cvt_pk_bf16_f32 v55, v58, v59
    v_lshlrev_b32 v48, 16, v52
    v_and_b32 v49, 0xffff0000, v52
    v_lshlrev_b32 v50, 16, v53
    v_and_b32 v51, 0xffff0000, v53
    v_lshlrev_b32 v56, 16, v54
    v_and_b32 v57, 0xffff0000, v54
    v_lshlrev_b32 v58, 16, v55
    v_and_b32 v59, 0xffff0000, v55
    v_add_f32 v48, v48, v56
    v_add_f32 v49, v49, v57
    v_add_f32 v50, v50, v58
    v_add_f32 v51, v51, v59
    v_cvt_pk_bf16_f32 v52, v48, v49
    v_cvt_pk_bf16_f32 v53, v50, v51
    global_store_dwordx2 v6, v[52:53], s[6:7] offset:0 sc1
    s_endpgm
L_cv_full:
    s_nop 3
    ds_read_b128 v[48:51], v6 offset:0
    ds_read_b128 v[52:55], v6 offset:256
    ds_read_b128 v[56:59], v6 offset:512
    ds_read_b128 v[60:63], v6 offset:768
    ds_read_b128 v[64:67], v6 offset:1024
    ds_read_b128 v[68:71], v6 offset:1280
    ds_read_b128 v[72:75], v6 offset:1536
    ds_read_b128 v[76:79], v6 offset:1792
    ds_read_b128 v[80:83], v6 offset:2048
    ds_read_b128 v[84:87], v6 offset:2304
    ds_read_b128 v[88:91], v6 offset:2560
    ds_read_b128 v[92:95], v6 offset:2816
    ds_read_b128 v[96:99], v6 offset:3072
    ds_read_b128 v[100:103], v6 offset:3328
    ds_read_b128 v[104:107], v6 offset:3584
    ds_read_b128 v[108:111], v6 offset:3840
    v_mov_b32 v16, 0
    v_mov_b32 v17, 0
    v_mov_b32 v18, 0
    v_mov_b32 v19, 0
    v_mov_b32 v20, 0
    v_mov_b32 v21, 0
    v_mov_b32 v22, 0
    v_mov_b32 v23, 0
    v_mov_b32 v24, 0
    v_mov_b32 v25, 0
    v_mov_b32 v26, 0
    v_mov_b32 v27, 0
    v_mov_b32 v28, 0
    v_mov_b32 v29, 0
    v_mov_b32 v30, 0
    v_mov_b32 v31, 0
    v_mov_b32 v32, 0
    v_mov_b32 v33, 0
    v_mov_b32 v34, 0
    v_mov_b32 v35, 0
    v_mov_b32 v36, 0
    v_mov_b32 v37, 0
    v_mov_b32 v38, 0
    v_mov_b32 v39, 0
    v_mov_b32 v40, 0
    v_mov_b32 v41, 0
    v_mov_b32 v42, 0
    v_mov_b32 v43, 0
    v_mov_b32 v44, 0
    v_mov_b32 v45, 0
    v_mov_b32 v46, 0
    v_mov_b32 v47, 0
    ds_read2_b32 v[112:113], v12 offset0:192 offset1:193
    ds_read2_b32 v[114:115], v12 offset0:194 offset1:195
    ds_read2_b32 v[116:117], v12 offset0:128 offset1:129
    ds_read2_b32 v[118:119], v12 offset0:130 offset1:131
    ds_read2_b32 v[120:121], v12 offset0:64 offset1:65
    ds_read2_b32 v[122:123], v12 offset0:66 offset1:67
    s_waitcnt lgkmcnt(4)
    v_mfma_f32_16x16x32_bf16 v[16:19], v[112:115], v[52:55], v[16:19]
    ds_read2_b32 v[124:125], v12 offset0:0 offset1:1
    ds_read2_b32 v[126:127], v12 offset0:2 offset1:3
    v_mfma_f32_16x16x32_bf16 v[20:23], v[112:115], v[60:63], v[20:23]
    v_mfma_f32_16x16x32_bf16 v[24:27], v[112:115], v[68:71], v[24:27]
    v_mfma_f32_16x16x32_bf16 v[28:31], v[112:115], v[76:79], v[28:31]
    v_mfma_f32_16x16x32_bf16 v[32:35], v[112:115], v[84:87], v[32:35]
    v_mfma_f32_16x16x32_bf16 v[36:39], v[112:115], v[92:95], v[36:39]
    v_mfma_f32_16x16x32_bf16 v[40:43], v[112:115], v[100:103], v[40:43]
    v_mfma_f32_16x16x32_bf16 v[44:47], v[112:115], v[108:111], v[44:47]
    s_waitcnt lgkmcnt(4)
    v_mfma_f32_16x16x32_bf16 v[16:19], v[116:119], v[48:51], v[16:19]
    ds_read2_b32 v[112:113], v13 offset0:192 offset1:193
    ds_read2_b32 v[114:115], v13 offset0:194 offset1:195
    v_mfma_f32_16x16x32_bf16 v[20:23], v[116:119], v[56:59], v[20:23]
    v_mfma_f32_16x16x32_bf16 v[24:27], v[116:119], v[64:67], v[24:27]
    v_mfma_f32_16x16x32_bf16 v[28:31], v[116:119], v[72:75], v[28:31]
    v_mfma_f32_16x16x32_bf16 v[32:35], v[116:119], v[80:83], v[32:35]
    v_mfma_f32_16x16x32_bf16 v[36:39], v[116:119], v[88:91], v[36:39]
    v_mfma_f32_16x16x32_bf16 v[40:43], v[116:119], v[96:99], v[40:43]
    v_mfma_f32_16x16x32_bf16 v[44:47], v[116:119], v[104:107], v[44:47]
    s_waitcnt lgkmcnt(4)
    v_mfma_f32_16x16x32_bf16 v[20:23], v[120:123], v[52:55], v[20:23]
    ds_read2_b32 v[116:117], v13 offset0:128 offset1:129
    ds_read2_b32 v[118:119], v13 offset0:130 offset1:131
    v_mfma_f32_16x16x32_bf16 v[24:27], v[120:123], v[60:63], v[24:27]
    v_mfma_f32_16x16x32_bf16 v[28:31], v[120:123], v[68:71], v[28:31]
    v_mfma_f32_16x16x32_bf16 v[32:35], v[120:123], v[76:79], v[32:35]
    v_mfma_f32_16x16x32_bf16 v[36:39], v[120:123], v[84:87], v[36:39]
    v_mfma_f32_16x16x32_bf16 v[40:43], v[120:123], v[92:95], v[40:43]
    v_mfma_f32_16x16x32_bf16 v[44:47], v[120:123], v[100:103], v[44:47]
    s_waitcnt lgkmcnt(4)
    v_mfma_f32_16x16x32_bf16 v[20:23], v[124:127], v[48:51], v[20:23]
    ds_read2_b32 v[120:121], v13 offset0:64 offset1:65
    ds_read2_b32 v[122:123], v13 offset0:66 offset1:67
    v_mfma_f32_16x16x32_bf16 v[24:27], v[124:127], v[56:59], v[24:27]
    v_mfma_f32_16x16x32_bf16 v[28:31], v[124:127], v[64:67], v[28:31]
    v_mfma_f32_16x16x32_bf16 v[32:35], v[124:127], v[72:75], v[32:35]
    v_mfma_f32_16x16x32_bf16 v[36:39], v[124:127], v[80:83], v[36:39]
    v_mfma_f32_16x16x32_bf16 v[40:43], v[124:127], v[88:91], v[40:43]
    v_mfma_f32_16x16x32_bf16 v[44:47], v[124:127], v[96:99], v[44:47]
    s_waitcnt lgkmcnt(4)
    v_mfma_f32_16x16x32_bf16 v[24:27], v[112:115], v[52:55], v[24:27]
    ds_read2_b32 v[124:125], v13 offset0:0 offset1:1
    ds_read2_b32 v[126:127], v13 offset0:2 offset1:3
    v_mfma_f32_16x16x32_bf16 v[28:31], v[112:115], v[60:63], v[28:31]
    v_mfma_f32_16x16x32_bf16 v[32:35], v[112:115], v[68:71], v[32:35]
    v_mfma_f32_16x16x32_bf16 v[36:39], v[112:115], v[76:79], v[36:39]
    v_mfma_f32_16x16x32_bf16 v[40:43], v[112:115], v[84:87], v[40:43]
    v_mfma_f32_16x16x32_bf16 v[44:47], v[112:115], v[92:95], v[44:47]
    s_waitcnt lgkmcnt(4)
    v_mfma_f32_16x16x32_bf16 v[24:27], v[116:119], v[48:51], v[24:27]
    ds_read2_b32 v[112:113], v14 offset0:192 offset1:193
    ds_read2_b32 v[114:115], v14 offset0:194 offset1:195
    v_mfma_f32_16x16x32_bf16 v[28:31], v[116:119], v[56:59], v[28:31]
    v_mfma_f32_16x16x32_bf16 v[32:35], v[116:119], v[64:67], v[32:35]
    v_mfma_f32_16x16x32_bf16 v[36:39], v[116:119], v[72:75], v[36:39]
    v_mfma_f32_16x16x32_bf16 v[40:43], v[116:119], v[80:83], v[40:43]
    v_mfma_f32_16x16x32_bf16 v[44:47], v[116:119], v[88:91], v[44:47]
    s_waitcnt lgkmcnt(4)
    v_mfma_f32_16x16x32_bf16 v[28:31], v[120:123], v[52:55], v[28:31]
    ds_read2_b32 v[116:117], v14 offset0:128 offset1:129
    ds_read2_b32 v[118:119], v14 offset0:130 offset1:131
    v_mfma_f32_16x16x32_bf16 v[32:35], v[120:123], v[60:63], v[32:35]
    v_mfma_f32_16x16x32_bf16 v[36:39], v[120:123], v[68:71], v[36:39]
    v_mfma_f32_16x16x32_bf16 v[40:43], v[120:123], v[76:79], v[40:43]
    v_mfma_f32_16x16x32_bf16 v[44:47], v[120:123], v[84:87], v[44:47]
    s_waitcnt lgkmcnt(4)
    v_mfma_f32_16x16x32_bf16 v[28:31], v[124:127], v[48:51], v[28:31]
    ds_read2_b32 v[120:121], v14 offset0:64 offset1:65
    ds_read2_b32 v[122:123], v14 offset0:66 offset1:67
    v_mfma_f32_16x16x32_bf16 v[32:35], v[124:127], v[56:59], v[32:35]
    v_mfma_f32_16x16x32_bf16 v[36:39], v[124:127], v[64:67], v[36:39]
    v_mfma_f32_16x16x32_bf16 v[40:43], v[124:127], v[72:75], v[40:43]
    v_mfma_f32_16x16x32_bf16 v[44:47], v[124:127], v[80:83], v[44:47]
    s_waitcnt lgkmcnt(4)
    v_mfma_f32_16x16x32_bf16 v[32:35], v[112:115], v[52:55], v[32:35]
    ds_read2_b32 v[124:125], v14 offset0:0 offset1:1
    ds_read2_b32 v[126:127], v14 offset0:2 offset1:3
    v_mfma_f32_16x16x32_bf16 v[36:39], v[112:115], v[60:63], v[36:39]
    v_mfma_f32_16x16x32_bf16 v[40:43], v[112:115], v[68:71], v[40:43]
    v_mfma_f32_16x16x32_bf16 v[44:47], v[112:115], v[76:79], v[44:47]
    s_waitcnt lgkmcnt(4)
    v_mfma_f32_16x16x32_bf16 v[32:35], v[116:119], v[48:51], v[32:35]
    ds_read2_b32 v[112:113], v15 offset0:192 offset1:193
    ds_read2_b32 v[114:115], v15 offset0:194 offset1:195
    v_mfma_f32_16x16x32_bf16 v[36:39], v[116:119], v[56:59], v[36:39]
    v_mfma_f32_16x16x32_bf16 v[40:43], v[116:119], v[64:67], v[40:43]
    v_mfma_f32_16x16x32_bf16 v[44:47], v[116:119], v[72:75], v[44:47]
    s_waitcnt lgkmcnt(4)
    v_mfma_f32_16x16x32_bf16 v[36:39], v[120:123], v[52:55], v[36:39]
    ds_read2_b32 v[116:117], v15 offset0:128 offset1:129
    ds_read2_b32 v[118:119], v15 offset0:130 offset1:131
    v_mfma_f32_16x16x32_bf16 v[40:43], v[120:123], v[60:63], v[40:43]
    v_mfma_f32_16x16x32_bf16 v[44:47], v[120:123], v[68:71], v[44:47]
    s_waitcnt lgkmcnt(4)
    v_mfma_f32_16x16x32_bf16 v[36:39], v[124:127], v[48:51], v[36:39]
    ds_read2_b32 v[120:121], v15 offset0:64 offset1:65
    ds_read2_b32 v[122:123], v15 offset0:66 offset1:67
    v_mfma_f32_16x16x32_bf16 v[40:43], v[124:127], v[56:59], v[40:43]
    v_mfma_f32_16x16x32_bf16 v[44:47], v[124:127], v[64:67], v[44:47]
    s_waitcnt lgkmcnt(4)
    v_mfma_f32_16x16x32_bf16 v[40:43], v[112:115], v[52:55], v[40:43]
    ds_read2_b32 v[124:125], v15 offset0:0 offset1:1
    ds_read2_b32 v[126:127], v15 offset0:2 offset1:3
    v_mfma_f32_16x16x32_bf16 v[44:47], v[112:115], v[60:63], v[44:47]
    s_waitcnt lgkmcnt(4)
    v_mfma_f32_16x16x32_bf16 v[40:43], v[116:119], v[48:51], v[40:43]
    v_mfma_f32_16x16x32_bf16 v[44:47], v[116:119], v[56:59], v[44:47]
    s_waitcnt lgkmcnt(2)
    v_mfma_f32_16x16x32_bf16 v[44:47], v[120:123], v[52:55], v[44:47]
    s_waitcnt lgkmcnt(0)
    v_mfma_f32_16x16x32_bf16 v[44:47], v[124:127], v[48:51], v[44:47]
    v_lshlrev_b32 v5, 13, v2
    v_lshl_add_u32 v5, v1, 4, v5
    v_add_u32 v5, s29, v5
    s_barrier
    ds_write_b128 v5, v[16:19] offset:8192
    ds_write_b128 v5, v[20:23] offset:9216
    ds_write_b128 v5, v[24:27] offset:10240
    ds_write_b128 v5, v[28:31] offset:11264
    ds_write_b128 v5, v[32:35] offset:12288
    ds_write_b128 v5, v[36:39] offset:13312
    ds_write_b128 v5, v[40:43] offset:14336
    ds_write_b128 v5, v[44:47] offset:15360
    v_lshlrev_b32 v5, 11, v2
    v_lshl_add_u32 v5, v1, 4, v5
    v_add_u32 v5, s29, v5
    v_lshlrev_b32 v6, 9, v2
    v_lshl_add_u32 v6, v3, 4, v6
    v_lshl_add_u32 v6, v4, 2, v6
    v_lshlrev_b32 v6, 1, v6
    v_add_u32 v7, s29, v6
    s_waitcnt lgkmcnt(0)
    s_barrier
    ds_read_b128 v[48:51], v5 offset:8192
    ds_read_b128 v[52:55], v5 offset:16384
    ds_read_b128 v[56:59], v5 offset:24576
    ds_read_b128 v[60:63], v5 offset:32768
    ds_read_b64 v[80:81], v7 offset:512
    ds_read_b128 v[64:67], v5 offset:9216
    ds_read_b128 v[68:71], v5 offset:17408
    ds_read_b128 v[72:75], v5 offset:25600
    ds_read_b128 v[76:79], v5 offset:33792
    ds_read_b64 v[82:83], v7 offset:1024
    v_lshlrev_b32 v9, 16, v9
    s_add_u32 s3, s3, 9437184
    v_add_u32 v6, s3, v6
    s_waitcnt lgkmcnt(5)
    v_add_f32 v48, v48, v52
    v_add_f32 v56, v56, v60
    v_add_f32 v49, v49, v53
    v_add_f32 v57, v57, v61
    v_add_f32 v50, v50, v54
    v_add_f32 v58, v58, v62
    v_add_f32 v51, v51, v55
    v_add_f32 v59, v59, v63
    v_add_f32 v48, v48, v56
    v_add_f32 v49, v49, v57
    v_add_f32 v50, v50, v58
    v_add_f32 v51, v51, v59
    v_cvt_pk_bf16_f32 v52, v48, v49
    v_cvt_pk_bf16_f32 v53, v50, v51
    v_lshlrev_b32 v56, 16, v80
    v_and_b32 v57, 0xffff0000, v80
    v_lshlrev_b32 v58, 16, v81
    v_and_b32 v59, 0xffff0000, v81
    v_mul_f32 v56, v9, v56
    v_mul_f32 v57, v9, v57
    v_mul_f32 v58, v9, v58
    v_mul_f32 v59, v9, v59
    v_cvt_pk_bf16_f32 v54, v56, v57
    v_cvt_pk_bf16_f32 v55, v58, v59
    v_lshlrev_b32 v48, 16, v52
    v_and_b32 v49, 0xffff0000, v52
    v_lshlrev_b32 v50, 16, v53
    v_and_b32 v51, 0xffff0000, v53
    v_lshlrev_b32 v56, 16, v54
    v_and_b32 v57, 0xffff0000, v54
    v_lshlrev_b32 v58, 16, v55
    v_and_b32 v59, 0xffff0000, v55
    v_add_f32 v48, v48, v56
    v_add_f32 v49, v49, v57
    v_add_f32 v50, v50, v58
    v_add_f32 v51, v51, v59
    v_cvt_pk_bf16_f32 v52, v48, v49
    v_cvt_pk_bf16_f32 v53, v50, v51
    global_store_dwordx2 v6, v[52:53], s[6:7] offset:0 sc1
    s_waitcnt lgkmcnt(0)
    v_add_f32 v64, v64, v68
    v_add_f32 v72, v72, v76
    v_add_f32 v65, v65, v69
    v_add_f32 v73, v73, v77
    v_add_f32 v66, v66, v70
    v_add_f32 v74, v74, v78
    v_add_f32 v67, v67, v71
    v_add_f32 v75, v75, v79
    v_add_f32 v64, v64, v72
    v_add_f32 v65, v65, v73
    v_add_f32 v66, v66, v74
    v_add_f32 v67, v67, v75
    v_cvt_pk_bf16_f32 v68, v64, v65
    v_cvt_pk_bf16_f32 v69, v66, v67
    v_lshlrev_b32 v72, 16, v82
    v_and_b32 v73, 0xffff0000, v82
    v_lshlrev_b32 v74, 16, v83
    v_and_b32 v75, 0xffff0000, v83
    v_mul_f32 v72, v9, v72
    v_mul_f32 v73, v9, v73
    v_mul_f32 v74, v9, v74
    v_mul_f32 v75, v9, v75
    v_cvt_pk_bf16_f32 v70, v72, v73
    v_cvt_pk_bf16_f32 v71, v74, v75
    v_lshlrev_b32 v64, 16, v68
    v_and_b32 v65, 0xffff0000, v68
    v_lshlrev_b32 v66, 16, v69
    v_and_b32 v67, 0xffff0000, v69
    v_lshlrev_b32 v72, 16, v70
    v_and_b32 v73, 0xffff0000, v70
    v_lshlrev_b32 v74, 16, v71
    v_and_b32 v75, 0xffff0000, v71
    v_add_f32 v64, v64, v72
    v_add_f32 v65, v65, v73
    v_add_f32 v66, v66, v74
    v_add_f32 v67, v67, v75
    v_cvt_pk_bf16_f32 v68, v64, v65
    v_cvt_pk_bf16_f32 v69, v66, v67
    global_store_dwordx2 v6, v[68:69], s[6:7] offset:512 sc1
    s_cmp_ge_u32 s30, 10
    s_cbranch_scc1 L_cv_end
    v_lshrrev_b32 v7, 6, v0
    s_nop 0
    v_readfirstlane_b32 s24, v7
    s_lshl_b32 s25, s30, 3
    s_nop 0
    s_add_u32 s24, s24, s25
    s_mul_i32 s24, s24, 18432
    v_mul_u32_u24 v7, 64, v1
    v_add_u32 v7, s24, v7
    s_mov_b32 s20, s32
    s_and_b32 s21, s33, 0xffff
    s_mov_b32 s22, 1409024
    s_mov_b32 s23, 0x00020000
    s_mov_b32 s24, 0
    buffer_load_dword v11, v7, s[20:23], s24 offen
    s_mov_b32 s24, 4096
    buffer_load_dword v11, v7, s[20:23], s24 offen
    s_mov_b32 s24, 8192
    buffer_load_dword v11, v7, s[20:23], s24 offen
    s_mov_b32 s24, 12288
    buffer_load_dword v11, v7, s[20:23], s24 offen
    s_mov_b32 s24, 16384
    buffer_load_dword v11, v7, s[20:23], s24 offen
    s_waitcnt vmcnt(0)
L_cv_end:
    s_endpgm
L_k2_exit:
    s_endpgm
.p2align 8
.type fin_kernel,@function
fin_kernel:
    s_cmp_ge_u32 s2, 256
    s_cbranch_scc1 L_k3_exit
    s_load_dwordx2 s[4:5], s[0:1], 88
    s_load_dwordx2 s[6:7], s[0:1], 112
    s_load_dwordx2 s[28:29], s[0:1], 0
    s_load_dwordx2 s[30:31], s[0:1], 96
    s_and_b32 s9, s2, 7
    s_lshr_b32 s8, s2, 5
    s_bfe_u32 s10, s2, 0x20003
    s_lshl_b32 s9, s9, 2
    s_add_u32 s9, s9, s10
    s_lshl_b32 s10, s8, 7
    s_mul_i32 s11, s9, 180224
    v_and_b32 v1, 63, v0
    v_lshrrev_b32 v2, 6, v0
    s_nop 0
    v_readfirstlane_b32 s12, v2
    v_and_b32 v2, 3, v2
    v_lshrrev_b32 v4, 3, v1
    v_and_b32 v5, 7, v1
    v_xor_b32 v6, v4, v5
    v_lshl_add_u32 v4, v2, 4, v4
    s_lshl_b32 s24, s9, 16
    s_add_u32 s24, s24, s10
    v_lshlrev_b32 v22, 10, v4
    v_lshl_add_u32 v22, v6, 4, v22
    v_add_u32 v22, s24, v22
    s_and_b32 s13, s12, 3
    s_lshl_b32 s13, s13, 11
    s_cmp_lt_u32 s12, 4
    s_cbranch_scc1 L_g2_comp
    v_lshlrev_b32 v3, 4, v1
    v_add_u32 v3, s13, v3
    v_add_u32 v8, s11, v3
    v_lshlrev_b32 v6, 1, v4
    v_and_b32 v6, 4, v6
    v_xor_b32 v6, v6, v5
    v_lshlrev_b32 v7, 10, v4
    v_lshl_add_u32 v7, v6, 4, v7
    v_add_u32 v10, s10, v7
    v_add_u32 v11, 7168, v10
    v_add_u32 v23, 7168, v22
    s_lshl_b32 s24, s8, 18
    s_lshl_b32 s25, s9, 7
    s_add_u32 s24, s24, s25
    s_add_u32 s24, s24, 9437184
    v_lshlrev_b32 v24, 12, v4
    v_lshl_add_u32 v24, v5, 4, v24
    v_add_u32 v24, s24, v24
    v_add_u32 v25, 31744, v24
    s_waitcnt lgkmcnt(0)
    s_mov_b32 s16, s6
    s_and_b32 s17, s7, 0xffff
    s_mov_b32 s18, 18350080
    s_mov_b32 s19, 0x00020000
    s_mov_b32 s20, s4
    s_and_b32 s21, s5, 0xffff
    s_mov_b32 s22, 1409024
    s_mov_b32 s23, 0x00020000
    s_mov_b32 s32, s28
    s_and_b32 s33, s29, 0xffff
    s_mov_b32 s34, 2097152
    s_mov_b32 s35, 0x00020000
    s_bfe_u32 s36, s2, 0x20003
    s_lshl_b32 s36, s36, 3
    s_add_u32 s36, s36, s8
    s_mul_i32 s36, s36, 11
    s_lshr_b32 s36, s36, 4
    s_lshl_b32 s25, s36, 13
    s_add_u32 s25, s25, 12582912
    s_lshl_b32 s26, s36, 16
    s_add_u32 s36, s36, 1
    s_cmp_eq_u32 s36, 22
    s_cselect_b32 s36, 0, s36
    s_add_u32 s24, s13, 0
    s_mov_b32 m0, s24
    s_add_u32 s27, s13, 8192
    buffer_load_dwordx4 v8, s[16:19], s25 offen offset:0 lds
    buffer_load_dwordx4 v8, s[16:19], s25 offen offset:1024 lds
    s_mov_b32 m0, s27
    s_nop 0
    buffer_load_dwordx4 v10, s[20:23], s26 offen lds
    buffer_load_dwordx4 v11, s[20:23], s26 offen offset:1024 lds
    s_lshl_b32 s25, s36, 13
    s_add_u32 s25, s25, 12582912
    s_lshl_b32 s26, s36, 16
    s_add_u32 s36, s36, 1
    s_cmp_eq_u32 s36, 22
    s_cselect_b32 s36, 0, s36
    s_add_u32 s24, s13, 16384
    s_mov_b32 m0, s24
    s_add_u32 s27, s13, 24576
    buffer_load_dwordx4 v8, s[16:19], s25 offen offset:0 lds
    buffer_load_dwordx4 v8, s[16:19], s25 offen offset:1024 lds
    s_mov_b32 m0, s27
    s_nop 0
    buffer_load_dwordx4 v10, s[20:23], s26 offen lds
    buffer_load_dwordx4 v11, s[20:23], s26 offen offset:1024 lds
    s_waitcnt vmcnt(4)
    s_barrier
    s_lshl_b32 s25, s36, 13
    s_add_u32 s25, s25, 12582912
    s_lshl_b32 s26, s36, 16
    s_add_u32 s36, s36, 1
    s_cmp_eq_u32 s36, 22
    s_cselect_b32 s36, 0, s36
    s_add_u32 s24, s13, 32768
    s_mov_b32 m0, s24
    s_add_u32 s27, s13, 40960
    buffer_load_dwordx4 v8, s[16:19], s25 offen offset:0 lds
    buffer_load_dwordx4 v8, s[16:19], s25 offen offset:1024 lds
    s_mov_b32 m0, s27
    s_nop 0
    buffer_load_dwordx4 v10, s[20:23], s26 offen lds
    buffer_load_dwordx4 v11, s[20:23], s26 offen offset:1024 lds
    s_lshl_b32 s25, s36, 13
    s_add_u32 s25, s25, 12582912
    s_lshl_b32 s26, s36, 16
    s_add_u32 s36, s36, 1
    s_cmp_eq_u32 s36, 22
    s_cselect_b32 s36, 0, s36
    s_add_u32 s24, s13, 49152
    s_mov_b32 m0, s24
    s_add_u32 s27, s13, 57344
    buffer_load_dwordx4 v8, s[16:19], s25 offen offset:0 lds
    buffer_load_dwordx4 v8, s[16:19], s25 offen offset:1024 lds
    s_mov_b32 m0, s27
    s_nop 0
    buffer_load_dwordx4 v10, s[20:23], s26 offen lds
    buffer_load_dwordx4 v11, s[20:23], s26 offen offset:1024 lds
    s_waitcnt vmcnt(8)
    s_barrier
    s_lshl_b32 s25, s36, 13
    s_add_u32 s25, s25, 12582912
    s_lshl_b32 s26, s36, 16
    s_add_u32 s36, s36, 1
    s_cmp_eq_u32 s36, 22
    s_cselect_b32 s36, 0, s36
    s_add_u32 s24, s13, 65536
    s_mov_b32 m0, s24
    s_add_u32 s27, s13, 73728
    buffer_load_dwordx4 v8, s[16:19], s25 offen offset:0 lds
    buffer_load_dwordx4 v8, s[16:19], s25 offen offset:1024 lds
    s_mov_b32 m0, s27
    s_nop 0
    buffer_load_dwordx4 v10, s[20:23], s26 offen lds
    buffer_load_dwordx4 v11, s[20:23], s26 offen offset:1024 lds
    s_lshl_b32 s25, s36, 13
    s_add_u32 s25, s25, 12582912
    s_lshl_b32 s26, s36, 16
    s_add_u32 s36, s36, 1
    s_cmp_eq_u32 s36, 22
    s_cselect_b32 s36, 0, s36
    s_add_u32 s24, s13, 81920
    s_mov_b32 m0, s24
    s_add_u32 s27, s13, 90112
    buffer_load_dwordx4 v8, s[16:19], s25 offen offset:0 lds
    buffer_load_dwordx4 v8, s[16:19], s25 offen offset:1024 lds
    s_mov_b32 m0, s27
    s_nop 0
    buffer_load_dwordx4 v10, s[20:23], s26 offen lds
    buffer_load_dwordx4 v11, s[20:23], s26 offen offset:1024 lds
    s_waitcnt vmcnt(12)
    s_barrier
    s_lshl_b32 s25, s36, 13
    s_add_u32 s25, s25, 12582912
    s_lshl_b32 s26, s36, 16
    s_add_u32 s36, s36, 1
    s_cmp_eq_u32 s36, 22
    s_cselect_b32 s36, 0, s36
    s_add_u32 s24, s13, 0
    s_mov_b32 m0, s24
    s_add_u32 s27, s13, 8192
    buffer_load_dwordx4 v8, s[16:19], s25 offen offset:0 lds
    buffer_load_dwordx4 v8, s[16:19], s25 offen offset:1024 lds
    s_mov_b32 m0, s27
    s_nop 0
    buffer_load_dwordx4 v10, s[20:23], s26 offen lds
    buffer_load_dwordx4 v11, s[20:23], s26 offen offset:1024 lds
    s_lshl_b32 s25, s36, 13
    s_add_u32 s25, s25, 12582912
    s_lshl_b32 s26, s36, 16
    s_add_u32 s36, s36, 1
    s_cmp_eq_u32 s36, 22
    s_cselect_b32 s36, 0, s36
    s_add_u32 s24, s13, 16384
    s_mov_b32 m0, s24
    s_add_u32 s27, s13, 24576
    buffer_load_dwordx4 v8, s[16:19], s25 offen offset:0 lds
    buffer_load_dwordx4 v8, s[16:19], s25 offen offset:1024 lds
    s_mov_b32 m0, s27
    s_nop 0
    buffer_load_dwordx4 v10, s[20:23], s26 offen lds
    buffer_load_dwordx4 v11, s[20:23], s26 offen offset:1024 lds
    s_waitcnt vmcnt(16)
    s_barrier
    s_lshl_b32 s25, s36, 13
    s_add_u32 s25, s25, 12582912
    s_lshl_b32 s26, s36, 16
    s_add_u32 s36, s36, 1
    s_cmp_eq_u32 s36, 22
    s_cselect_b32 s36, 0, s36
    s_add_u32 s24, s13, 32768
    s_mov_b32 m0, s24
    s_add_u32 s27, s13, 40960
    buffer_load_dwordx4 v8, s[16:19], s25 offen offset:0 lds
    buffer_load_dwordx4 v8, s[16:19], s25 offen offset:1024 lds
    s_mov_b32 m0, s27
    s_nop 0
    buffer_load_dwordx4 v10, s[20:23], s26 offen lds
    buffer_load_dwordx4 v11, s[20:23], s26 offen offset:1024 lds
    s_waitcnt vmcnt(16)
    s_barrier
    s_lshl_b32 s25, s36, 13
    s_add_u32 s25, s25, 12582912
    s_lshl_b32 s26, s36, 16
    s_add_u32 s36, s36, 1
    s_cmp_eq_u32 s36, 22
    s_cselect_b32 s36, 0, s36
    s_add_u32 s24, s13, 49152
    s_mov_b32 m0, s24
    s_add_u32 s27, s13, 57344
    buffer_load_dwordx4 v8, s[16:19], s25 offen offset:0 lds
    buffer_load_dwordx4 v8, s[16:19], s25 offen offset:1024 lds
    s_mov_b32 m0, s27
    s_nop 0
    buffer_load_dwordx4 v10, s[20:23], s26 offen lds
    buffer_load_dwordx4 v11, s[20:23], s26 offen offset:1024 lds
    s_waitcnt vmcnt(16)
    s_barrier
    s_lshl_b32 s25, s36, 13
    s_add_u32 s25, s25, 12582912
    s_lshl_b32 s26, s36, 16
    s_add_u32 s36, s36, 1
    s_cmp_eq_u32 s36, 22
    s_cselect_b32 s36, 0, s36
    s_add_u32 s24, s13, 65536
    s_mov_b32 m0, s24
    s_add_u32 s27, s13, 73728
    buffer_load_dwordx4 v8, s[16:19], s25 offen offset:0 lds
    buffer_load_dwordx4 v8, s[16:19], s25 offen offset:1024 lds
    s_mov_b32 m0, s27
    s_nop 0
    buffer_load_dwordx4 v10, s[20:23], s26 offen lds
    buffer_load_dwordx4 v11, s[20:23], s26 offen offset:1024 lds
    s_waitcnt vmcnt(16)
    s_barrier
    s_lshl_b32 s25, s36, 13
    s_add_u32 s25, s25, 12582912
    s_lshl_b32 s26, s36, 16
    s_add_u32 s36, s36, 1
    s_cmp_eq_u32 s36, 22
    s_cselect_b32 s36, 0, s36
    s_add_u32 s24, s13, 81920
    s_mov_b32 m0, s24
    s_add_u32 s27, s13, 90112
    buffer_load_dwordx4 v8, s[16:19], s25 offen offset:0 lds
    buffer_load_dwordx4 v8, s[16:19], s25 offen offset:1024 lds
    s_mov_b32 m0, s27
    s_nop 0
    buffer_load_dwordx4 v10, s[20:23], s26 offen lds
    buffer_load_dwordx4 v11, s[20:23], s26 offen offset:1024 lds
    s_waitcnt vmcnt(16)
    s_barrier
    s_lshl_b32 s25, s36, 13
    s_add_u32 s25, s25, 12582912
    s_lshl_b32 s26, s36, 16
    s_add_u32 s36, s36, 1
    s_cmp_eq_u32 s36, 22
    s_cselect_b32 s36, 0, s36
    s_add_u32 s24, s13, 0
    s_mov_b32 m0, s24
    s_add_u32 s27, s13, 8192
    buffer_load_dwordx4 v8, s[16:19], s25 offen offset:0 lds
    buffer_load_dwordx4 v8, s[16:19], s25 offen offset:1024 lds
    s_mov_b32 m0, s27
    s_nop 0
    buffer_load_dwordx4 v10, s[20:23], s26 offen lds
    buffer_load_dwordx4 v11, s[20:23], s26 offen offset:1024 lds
    s_waitcnt vmcnt(16)
    s_barrier
    s_lshl_b32 s25, s36, 13
    s_add_u32 s25, s25, 12582912
    s_lshl_b32 s26, s36, 16
    s_add_u32 s36, s36, 1
    s_cmp_eq_u32 s36, 22
    s_cselect_b32 s36, 0, s36
    s_add_u32 s24, s13, 16384
    s_mov_b32 m0, s24
    s_add_u32 s27, s13, 24576
    buffer_load_dwordx4 v8, s[16:19], s25 offen offset:0 lds
    buffer_load_dwordx4 v8, s[16:19], s25 offen offset:1024 lds
    s_mov_b32 m0, s27
    s_nop 0
    buffer_load_dwordx4 v10, s[20:23], s26 offen lds
    buffer_load_dwordx4 v11, s[20:23], s26 offen offset:1024 lds
    s_waitcnt vmcnt(16)
    s_barrier
    s_lshl_b32 s25, s36, 13
    s_add_u32 s25, s25, 12582912
    s_lshl_b32 s26, s36, 16
    s_add_u32 s36, s36, 1
    s_cmp_eq_u32 s36, 22
    s_cselect_b32 s36, 0, s36
    s_add_u32 s24, s13, 32768
    s_mov_b32 m0, s24
    s_add_u32 s27, s13, 40960
    buffer_load_dwordx4 v8, s[16:19], s25 offen offset:0 lds
    buffer_load_dwordx4 v8, s[16:19], s25 offen offset:1024 lds
    s_mov_b32 m0, s27
    s_nop 0
    buffer_load_dwordx4 v10, s[20:23], s26 offen lds
    buffer_load_dwordx4 v11, s[20:23], s26 offen offset:1024 lds
    s_waitcnt vmcnt(16)
    s_barrier
    s_lshl_b32 s25, s36, 13
    s_add_u32 s25, s25, 12582912
    s_lshl_b32 s26, s36, 16
    s_add_u32 s36, s36, 1
    s_cmp_eq_u32 s36, 22
    s_cselect_b32 s36, 0, s36
    s_add_u32 s24, s13, 49152
    s_mov_b32 m0, s24
    s_add_u32 s27, s13, 57344
    buffer_load_dwordx4 v8, s[16:19], s25 offen offset:0 lds
    buffer_load_dwordx4 v8, s[16:19], s25 offen offset:1024 lds
    s_mov_b32 m0, s27
    s_nop 0
    buffer_load_dwordx4 v10, s[20:23], s26 offen lds
    buffer_load_dwordx4 v11, s[20:23], s26 offen offset:1024 lds
    s_add_u32 s24, s13, 98304
    s_mov_b32 m0, s24
    s_add_u32 s27, s13, 106496
    buffer_load_dwordx4 v22, s[32:35], 0 offen lds
    buffer_load_dwordx4 v23, s[32:35], 0 offen offset:1024 lds
    s_mov_b32 m0, s27
    s_nop 0
    buffer_load_dwordx4 v24, s[16:19], 0 offen lds
    buffer_load_dwordx4 v25, s[16:19], 0 offen offset:1024 lds
    s_waitcnt vmcnt(20)
    s_barrier
    s_lshl_b32 s25, s36, 13
    s_add_u32 s25, s25, 12582912
    s_lshl_b32 s26, s36, 16
    s_add_u32 s36, s36, 1
    s_cmp_eq_u32 s36, 22
    s_cselect_b32 s36, 0, s36
    s_add_u32 s24, s13, 65536
    s_mov_b32 m0, s24
    s_add_u32 s27, s13, 73728
    buffer_load_dwordx4 v8, s[16:19], s25 offen offset:0 lds
    buffer_load_dwordx4 v8, s[16:19], s25 offen offset:1024 lds
    s_mov_b32 m0, s27
    s_nop 0
    buffer_load_dwordx4 v10, s[20:23], s26 offen lds
    buffer_load_dwordx4 v11, s[20:23], s26 offen offset:1024 lds
    s_waitcnt vmcnt(20)
    s_barrier
    s_lshl_b32 s25, s36, 13
    s_add_u32 s25, s25, 12582912
    s_lshl_b32 s26, s36, 16
    s_add_u32 s36, s36, 1
    s_cmp_eq_u32 s36, 22
    s_cselect_b32 s36, 0, s36
    s_add_u32 s24, s13, 81920
    s_mov_b32 m0, s24
    s_add_u32 s27, s13, 90112
    buffer_load_dwordx4 v8, s[16:19], s25 offen offset:0 lds
    buffer_load_dwordx4 v8, s[16:19], s25 offen offset:1024 lds
    s_mov_b32 m0, s27
    s_nop 0
    buffer_load_dwordx4 v10, s[20:23], s26 offen lds
    buffer_load_dwordx4 v11, s[20:23], s26 offen offset:1024 lds
    s_waitcnt vmcnt(20)
    s_barrier
    s_lshl_b32 s25, s36, 13
    s_add_u32 s25, s25, 12582912
    s_lshl_b32 s26, s36, 16
    s_add_u32 s36, s36, 1
    s_cmp_eq_u32 s36, 22
    s_cselect_b32 s36, 0, s36
    s_add_u32 s24, s13, 0
    s_mov_b32 m0, s24
    s_add_u32 s27, s13, 8192
    buffer_load_dwordx4 v8, s[16:19], s25 offen offset:0 lds
    buffer_load_dwordx4 v8, s[16:19], s25 offen offset:1024 lds
    s_mov_b32 m0, s27
    s_nop 0
    buffer_load_dwordx4 v10, s[20:23], s26 offen lds
    buffer_load_dwordx4 v11, s[20:23], s26 offen offset:1024 lds
    s_waitcnt vmcnt(20)
    s_barrier
    s_lshl_b32 s25, s36, 13
    s_add_u32 s25, s25, 12582912
    s_lshl_b32 s26, s36, 16
    s_add_u32 s36, s36, 1
    s_cmp_eq_u32 s36, 22
    s_cselect_b32 s36, 0, s36
    s_add_u32 s24, s13, 16384
    s_mov_b32 m0, s24
    s_add_u32 s27, s13, 24576
    buffer_load_dwordx4 v8, s[16:19], s25 offen offset:0 lds
    buffer_load_dwordx4 v8, s[16:19], s25 offen offset:1024 lds
    s_mov_b32 m0, s27
    s_nop 0
    buffer_load_dwordx4 v10, s[20:23], s26 offen lds
    buffer_load_dwordx4 v11, s[20:23], s26 offen offset:1024 lds
    s_waitcnt vmcnt(20)
    s_barrier
    s_lshl_b32 s25, s36, 13
    s_add_u32 s25, s25, 12582912
    s_lshl_b32 s26, s36, 16
    s_add_u32 s36, s36, 1
    s_cmp_eq_u32 s36, 22
    s_cselect_b32 s36, 0, s36
    s_add_u32 s24, s13, 32768
    s_mov_b32 m0, s24
    s_add_u32 s27, s13, 40960
    buffer_load_dwordx4 v8, s[16:19], s25 offen offset:0 lds
    buffer_load_dwordx4 v8, s[16:19], s25 offen offset:1024 lds
    s_mov_b32 m0, s27
    s_nop 0
    buffer_load_dwordx4 v10, s[20:23], s26 offen lds
    buffer_load_dwordx4 v11, s[20:23], s26 offen offset:1024 lds
    s_waitcnt vmcnt(16)
    s_barrier
    s_lshl_b32 s25, s36, 13
    s_add_u32 s25, s25, 12582912
    s_lshl_b32 s26, s36, 16
    s_add_u32 s36, s36, 1
    s_cmp_eq_u32 s36, 22
    s_cselect_b32 s36, 0, s36
    s_add_u32 s24, s13, 49152
    s_mov_b32 m0, s24
    s_add_u32 s27, s13, 57344
    buffer_load_dwordx4 v8, s[16:19], s25 offen offset:0 lds
    buffer_load_dwordx4 v8, s[16:19], s25 offen offset:1024 lds
    s_mov_b32 m0, s27
    s_nop 0
    buffer_load_dwordx4 v10, s[20:23], s26 offen lds
    buffer_load_dwordx4 v11, s[20:23], s26 offen offset:1024 lds
    s_waitcnt vmcnt(16)
    s_barrier
    s_waitcnt vmcnt(12)
    s_barrier
    s_waitcnt vmcnt(8)
    s_barrier
    s_waitcnt vmcnt(4)
    s_barrier
    s_waitcnt vmcnt(0)
    s_barrier
    s_endpgm
L_g2_comp:
    s_nop 3
    v_and_b32 v4, 31, v1
    v_lshrrev_b32 v5, 5, v1
    v_and_b32 v6, 1, v2
    v_lshl_add_u32 v4, v6, 5, v4
    v_lshrrev_b32 v6, 1, v4
    v_and_b32 v6, 7, v6
    v_add_u32 v7, 0, v5
    v_xor_b32 v7, v7, v6
    v_lshlrev_b32 v7, 4, v7
    v_lshl_add_u32 v12, v4, 7, v7
    v_add_u32 v16, 49152, v12
    v_add_u32 v7, 2, v5
    v_xor_b32 v7, v7, v6
    v_lshlrev_b32 v7, 4, v7
    v_lshl_add_u32 v13, v4, 7, v7
    v_add_u32 v17, 49152, v13
    v_add_u32 v7, 4, v5
    v_xor_b32 v7, v7, v6
    v_lshlrev_b32 v7, 4, v7
    v_lshl_add_u32 v14, v4, 7, v7
    v_add_u32 v18, 49152, v14
    v_add_u32 v7, 6, v5
    v_xor_b32 v7, v7, v6
    v_lshlrev_b32 v7, 4, v7
    v_lshl_add_u32 v15, v4, 7, v7
    v_add_u32 v19, 49152, v15
    v_lshrrev_b32 v3, 1, v2
    v_and_b32 v6, 7, v4
    v_lshlrev_b32 v8, 7, v4
    v_lshl_add_u32 v8, v5, 3, v8
    v_add_u32 v8, 98304, v8
    v_lshl_add_u32 v7, v3, 2, 0
    v_xor_b32 v7, v7, v6
    v_lshl_add_u32 v24, v7, 4, v8
    v_lshl_add_u32 v7, v3, 2, 1
    v_xor_b32 v7, v7, v6
    v_lshl_add_u32 v25, v7, 4, v8
    v_lshl_add_u32 v7, v3, 2, 2
    v_xor_b32 v7, v7, v6
    v_lshl_add_u32 v26, v7, 4, v8
    v_lshl_add_u32 v7, v3, 2, 3
    v_xor_b32 v7, v7, v6
    v_lshl_add_u32 v27, v7, 4, v8
    v_lshlrev_b32 v28, 5, v3
    v_lshl_add_u32 v28, v5, 2, v28
    v_lshlrev_b32 v28, 7, v28
    v_lshl_add_u32 v28, v4, 1, v28
    v_add_u32 v28, 106496, v28
    v_lshlrev_b32 v29, 4, v1
    v_add_u32 v29, s13, v29
    v_add_u32 v29, 98304, v29
    v_and_b32 v4, 15, v1
    v_lshrrev_b32 v5, 4, v1
    v_lshrrev_b32 v6, 1, v5
    v_lshrrev_b32 v7, 2, v4
    v_lshl_add_u32 v7, v6, 3, v7
    v_lshlrev_b32 v7, 7, v7
    v_and_b32 v6, 1, v4
    v_lshl_add_u32 v7, v6, 3, v7
    v_add_u32 v7, 8192, v7
    v_and_b32 v5, 1, v5
    v_lshlrev_b32 v5, 1, v5
    v_bfe_u32 v6, v4, 1, 1
    v_add_u32 v5, v5, v6
    v_lshl_add_u32 v5, v3, 2, v5
    v_lshrrev_b32 v6, 1, v4
    v_and_b32 v6, 4, v6
    v_xor_b32 v5, v5, v6
    v_lshl_add_u32 v20, v5, 4, v7
    v_add_u32 v21, 49152, v20
    v_mov_b32 v32, 0
    v_mov_b32 v33, 0
    v_mov_b32 v34, 0
    v_mov_b32 v35, 0
    v_mov_b32 v36, 0
    v_mov_b32 v37, 0
    v_mov_b32 v38, 0
    v_mov_b32 v39, 0
    v_mov_b32 v40, 0
    v_mov_b32 v41, 0
    v_mov_b32 v42, 0
    v_mov_b32 v43, 0
    v_mov_b32 v44, 0
    v_mov_b32 v45, 0
    v_mov_b32 v46, 0
    v_mov_b32 v47, 0
    s_waitcnt lgkmcnt(0)
    s_barrier
    ds_read_b128 v[48:51], v12 offset:0
    ds_read_b64_tr_b16 v[52:53], v20 offset:0
    ds_read_b64_tr_b16 v[54:55], v20 offset:512
    ds_read_b128 v[56:59], v13 offset:0
    ds_read_b64_tr_b16 v[60:61], v20 offset:2048
    ds_read_b64_tr_b16 v[62:63], v20 offset:2560
    ds_read_b128 v[64:67], v14 offset:0
    ds_read_b64_tr_b16 v[68:69], v20 offset:4096
    ds_read_b64_tr_b16 v[70:71], v20 offset:4608
    ds_read_b128 v[72:75], v15 offset:0
    ds_read_b64_tr_b16 v[76:77], v20 offset:6144
    ds_read_b64_tr_b16 v[78:79], v20 offset:6656
    s_waitcnt lgkmcnt(0)
    s_barrier
    ds_read_b128 v[80:83], v12 offset:16384
    ds_read_b64_tr_b16 v[84:85], v20 offset:16384
    ds_read_b64_tr_b16 v[86:87], v20 offset:16896
    v_mfma_f32_32x32x16_bf16 v[32:47], v[52:55], v[48:51], v[32:47]
    ds_read_b128 v[88:91], v13 offset:16384
    ds_read_b64_tr_b16 v[92:93], v20 offset:18432
    ds_read_b64_tr_b16 v[94:95], v20 offset:18944
    v_mfma_f32_32x32x16_bf16 v[32:47], v[60:63], v[56:59], v[32:47]
    ds_read_b128 v[96:99], v14 offset:16384
    ds_read_b64_tr_b16 v[100:101], v20 offset:20480
    ds_read_b64_tr_b16 v[102:103], v20 offset:20992
    v_mfma_f32_32x32x16_bf16 v[32:47], v[68:71], v[64:67], v[32:47]
    ds_read_b128 v[104:107], v15 offset:16384
    ds_read_b64_tr_b16 v[108:109], v20 offset:22528
    ds_read_b64_tr_b16 v[110:111], v20 offset:23040
    v_mfma_f32_32x32x16_bf16 v[32:47], v[76:79], v[72:75], v[32:47]
    s_waitcnt lgkmcnt(0)
    s_barrier
    ds_read_b128 v[48:51], v12 offset:32768
    ds_read_b64_tr_b16 v[52:53], v20 offset:32768
    ds_read_b64_tr_b16 v[54:55], v20 offset:33280
    v_mfma_f32_32x32x16_bf16 v[32:47], v[84:87], v[80:83], v[32:47]
    ds_read_b128 v[56:59], v13 offset:32768
    ds_read_b64_tr_b16 v[60:61], v20 offset:34816
    ds_read_b64_tr_b16 v[62:63], v20 offset:35328
    v_mfma_f32_32x32x16_bf16 v[32:47], v[92:95], v[88:91], v[32:47]
    ds_read_b128 v[64:67], v14 offset:32768
    ds_read_b64_tr_b16 v[68:69], v20 offset:36864
    ds_read_b64_tr_b16 v[70:71], v20 offset:37376
    v_mfma_f32_32x32x16_bf16 v[32:47], v[100:103], v[96:99], v[32:47]
    ds_read_b128 v[72:75], v15 offset:32768
    ds_read_b64_tr_b16 v[76:77], v20 offset:38912
    ds_read_b64_tr_b16 v[78:79], v20 offset:39424
    v_mfma_f32_32x32x16_bf16 v[32:47], v[108:111], v[104:107], v[32:47]
    s_waitcnt lgkmcnt(0)
    s_barrier
    ds_read_b128 v[80:83], v16 offset:0
    ds_read_b64_tr_b16 v[84:85], v21 offset:0
    ds_read_b64_tr_b16 v[86:87], v21 offset:512
    v_mfma_f32_32x32x16_bf16 v[32:47], v[52:55], v[48:51], v[32:47]
    ds_read_b128 v[88:91], v17 offset:0
    ds_read_b64_tr_b16 v[92:93], v21 offset:2048
    ds_read_b64_tr_b16 v[94:95], v21 offset:2560
    v_mfma_f32_32x32x16_bf16 v[32:47], v[60:63], v[56:59], v[32:47]
    ds_read_b128 v[96:99], v18 offset:0
    ds_read_b64_tr_b16 v[100:101], v21 offset:4096
    ds_read_b64_tr_b16 v[102:103], v21 offset:4608
    v_mfma_f32_32x32x16_bf16 v[32:47], v[68:71], v[64:67], v[32:47]
    ds_read_b128 v[104:107], v19 offset:0
    ds_read_b64_tr_b16 v[108:109], v21 offset:6144
    ds_read_b64_tr_b16 v[110:111], v21 offset:6656
    v_mfma_f32_32x32x16_bf16 v[32:47], v[76:79], v[72:75], v[32:47]
    s_waitcnt lgkmcnt(0)
    s_barrier
    ds_read_b128 v[48:51], v16 offset:16384
    ds_read_b64_tr_b16 v[52:53], v21 offset:16384
    ds_read_b64_tr_b16 v[54:55], v21 offset:16896
    v_mfma_f32_32x32x16_bf16 v[32:47], v[84:87], v[80:83], v[32:47]
    ds_read_b128 v[56:59], v17 offset:16384
    ds_read_b64_tr_b16 v[60:61], v21 offset:18432
    ds_read_b64_tr_b16 v[62:63], v21 offset:18944
    v_mfma_f32_32x32x16_bf16 v[32:47], v[92:95], v[88:91], v[32:47]
    ds_read_b128 v[64:67], v18 offset:16384
    ds_read_b64_tr_b16 v[68:69], v21 offset:20480
    ds_read_b64_tr_b16 v[70:71], v21 offset:20992
    v_mfma_f32_32x32x16_bf16 v[32:47], v[100:103], v[96:99], v[32:47]
    ds_read_b128 v[72:75], v19 offset:16384
    ds_read_b64_tr_b16 v[76:77], v21 offset:22528
    ds_read_b64_tr_b16 v[78:79], v21 offset:23040
    v_mfma_f32_32x32x16_bf16 v[32:47], v[108:111], v[104:107], v[32:47]
    s_waitcnt lgkmcnt(0)
    s_barrier
    ds_read_b128 v[80:83], v16 offset:32768
    ds_read_b64_tr_b16 v[84:85], v21 offset:32768
    ds_read_b64_tr_b16 v[86:87], v21 offset:33280
    v_mfma_f32_32x32x16_bf16 v[32:47], v[52:55], v[48:51], v[32:47]
    ds_read_b128 v[88:91], v17 offset:32768
    ds_read_b64_tr_b16 v[92:93], v21 offset:34816
    ds_read_b64_tr_b16 v[94:95], v21 offset:35328
    v_mfma_f32_32x32x16_bf16 v[32:47], v[60:63], v[56:59], v[32:47]
    ds_read_b128 v[96:99], v18 offset:32768
    ds_read_b64_tr_b16 v[100:101], v21 offset:36864
    ds_read_b64_tr_b16 v[102:103], v21 offset:37376
    v_mfma_f32_32x32x16_bf16 v[32:47], v[68:71], v[64:67], v[32:47]
    ds_read_b128 v[104:107], v19 offset:32768
    ds_read_b64_tr_b16 v[108:109], v21 offset:38912
    ds_read_b64_tr_b16 v[110:111], v21 offset:39424
    v_mfma_f32_32x32x16_bf16 v[32:47], v[76:79], v[72:75], v[32:47]
    s_waitcnt lgkmcnt(0)
    s_barrier
    ds_read_b128 v[48:51], v12 offset:0
    ds_read_b64_tr_b16 v[52:53], v20 offset:0
    ds_read_b64_tr_b16 v[54:55], v20 offset:512
    v_mfma_f32_32x32x16_bf16 v[32:47], v[84:87], v[80:83], v[32:47]
    ds_read_b128 v[56:59], v13 offset:0
    ds_read_b64_tr_b16 v[60:61], v20 offset:2048
    ds_read_b64_tr_b16 v[62:63], v20 offset:2560
    v_mfma_f32_32x32x16_bf16 v[32:47], v[92:95], v[88:91], v[32:47]
    ds_read_b128 v[64:67], v14 offset:0
    ds_read_b64_tr_b16 v[68:69], v20 offset:4096
    ds_read_b64_tr_b16 v[70:71], v20 offset:4608
    v_mfma_f32_32x32x16_bf16 v[32:47], v[100:103], v[96:99], v[32:47]
    ds_read_b128 v[72:75], v15 offset:0
    ds_read_b64_tr_b16 v[76:77], v20 offset:6144
    ds_read_b64_tr_b16 v[78:79], v20 offset:6656
    v_mfma_f32_32x32x16_bf16 v[32:47], v[108:111], v[104:107], v[32:47]
    s_waitcnt lgkmcnt(0)
    s_barrier
    ds_read_b128 v[80:83], v12 offset:16384
    ds_read_b64_tr_b16 v[84:85], v20 offset:16384
    ds_read_b64_tr_b16 v[86:87], v20 offset:16896
    v_mfma_f32_32x32x16_bf16 v[32:47], v[52:55], v[48:51], v[32:47]
    ds_read_b128 v[88:91], v13 offset:16384
    ds_read_b64_tr_b16 v[92:93], v20 offset:18432
    ds_read_b64_tr_b16 v[94:95], v20 offset:18944
    v_mfma_f32_32x32x16_bf16 v[32:47], v[60:63], v[56:59], v[32:47]
    ds_read_b128 v[96:99], v14 offset:16384
    ds_read_b64_tr_b16 v[100:101], v20 offset:20480
    ds_read_b64_tr_b16 v[102:103], v20 offset:20992
    v_mfma_f32_32x32x16_bf16 v[32:47], v[68:71], v[64:67], v[32:47]
    ds_read_b128 v[104:107], v15 offset:16384
    ds_read_b64_tr_b16 v[108:109], v20 offset:22528
    ds_read_b64_tr_b16 v[110:111], v20 offset:23040
    v_mfma_f32_32x32x16_bf16 v[32:47], v[76:79], v[72:75], v[32:47]
    s_waitcnt lgkmcnt(0)
    s_barrier
    ds_read_b128 v[48:51], v12 offset:32768
    ds_read_b64_tr_b16 v[52:53], v20 offset:32768
    ds_read_b64_tr_b16 v[54:55], v20 offset:33280
    v_mfma_f32_32x32x16_bf16 v[32:47], v[84:87], v[80:83], v[32:47]
    ds_read_b128 v[56:59], v13 offset:32768
    ds_read_b64_tr_b16 v[60:61], v20 offset:34816
    ds_read_b64_tr_b16 v[62:63], v20 offset:35328
    v_mfma_f32_32x32x16_bf16 v[32:47], v[92:95], v[88:91], v[32:47]
    ds_read_b128 v[64:67], v14 offset:32768
    ds_read_b64_tr_b16 v[68:69], v20 offset:36864
    ds_read_b64_tr_b16 v[70:71], v20 offset:37376
    v_mfma_f32_32x32x16_bf16 v[32:47], v[100:103], v[96:99], v[32:47]
    ds_read_b128 v[72:75], v15 offset:32768
    ds_read_b64_tr_b16 v[76:77], v20 offset:38912
    ds_read_b64_tr_b16 v[78:79], v20 offset:39424
    v_mfma_f32_32x32x16_bf16 v[32:47], v[108:111], v[104:107], v[32:47]
    s_waitcnt lgkmcnt(0)
    s_barrier
    ds_read_b128 v[80:83], v16 offset:0
    ds_read_b64_tr_b16 v[84:85], v21 offset:0
    ds_read_b64_tr_b16 v[86:87], v21 offset:512
    v_mfma_f32_32x32x16_bf16 v[32:47], v[52:55], v[48:51], v[32:47]
    ds_read_b128 v[88:91], v17 offset:0
    ds_read_b64_tr_b16 v[92:93], v21 offset:2048
    ds_read_b64_tr_b16 v[94:95], v21 offset:2560
    v_mfma_f32_32x32x16_bf16 v[32:47], v[60:63], v[56:59], v[32:47]
    ds_read_b128 v[96:99], v18 offset:0
    ds_read_b64_tr_b16 v[100:101], v21 offset:4096
    ds_read_b64_tr_b16 v[102:103], v21 offset:4608
    v_mfma_f32_32x32x16_bf16 v[32:47], v[68:71], v[64:67], v[32:47]
    ds_read_b128 v[104:107], v19 offset:0
    ds_read_b64_tr_b16 v[108:109], v21 offset:6144
    ds_read_b64_tr_b16 v[110:111], v21 offset:6656
    v_mfma_f32_32x32x16_bf16 v[32:47], v[76:79], v[72:75], v[32:47]
    s_waitcnt lgkmcnt(0)
    s_barrier
    ds_read_b128 v[48:51], v16 offset:16384
    ds_read_b64_tr_b16 v[52:53], v21 offset:16384
    ds_read_b64_tr_b16 v[54:55], v21 offset:16896
    v_mfma_f32_32x32x16_bf16 v[32:47], v[84:87], v[80:83], v[32:47]
    ds_read_b128 v[56:59], v17 offset:16384
    ds_read_b64_tr_b16 v[60:61], v21 offset:18432
    ds_read_b64_tr_b16 v[62:63], v21 offset:18944
    v_mfma_f32_32x32x16_bf16 v[32:47], v[92:95], v[88:91], v[32:47]
    ds_read_b128 v[64:67], v18 offset:16384
    ds_read_b64_tr_b16 v[68:69], v21 offset:20480
    ds_read_b64_tr_b16 v[70:71], v21 offset:20992
    v_mfma_f32_32x32x16_bf16 v[32:47], v[100:103], v[96:99], v[32:47]
    ds_read_b128 v[72:75], v19 offset:16384
    ds_read_b64_tr_b16 v[76:77], v21 offset:22528
    ds_read_b64_tr_b16 v[78:79], v21 offset:23040
    v_mfma_f32_32x32x16_bf16 v[32:47], v[108:111], v[104:107], v[32:47]
    s_waitcnt lgkmcnt(0)
    s_barrier
    ds_read_b128 v[80:83], v16 offset:32768
    ds_read_b64_tr_b16 v[84:85], v21 offset:32768
    ds_read_b64_tr_b16 v[86:87], v21 offset:33280
    v_mfma_f32_32x32x16_bf16 v[32:47], v[52:55], v[48:51], v[32:47]
    ds_read_b128 v[88:91], v17 offset:32768
    ds_read_b64_tr_b16 v[92:93], v21 offset:34816
    ds_read_b64_tr_b16 v[94:95], v21 offset:35328
    v_mfma_f32_32x32x16_bf16 v[32:47], v[60:63], v[56:59], v[32:47]
    ds_read_b128 v[96:99], v18 offset:32768
    ds_read_b64_tr_b16 v[100:101], v21 offset:36864
    ds_read_b64_tr_b16 v[102:103], v21 offset:37376
    v_mfma_f32_32x32x16_bf16 v[32:47], v[68:71], v[64:67], v[32:47]
    ds_read_b128 v[104:107], v19 offset:32768
    ds_read_b64_tr_b16 v[108:109], v21 offset:38912
    ds_read_b64_tr_b16 v[110:111], v21 offset:39424
    v_mfma_f32_32x32x16_bf16 v[32:47], v[76:79], v[72:75], v[32:47]
    s_waitcnt lgkmcnt(0)
    s_barrier
    ds_read_b128 v[48:51], v12 offset:0
    ds_read_b64_tr_b16 v[52:53], v20 offset:0
    ds_read_b64_tr_b16 v[54:55], v20 offset:512
    v_mfma_f32_32x32x16_bf16 v[32:47], v[84:87], v[80:83], v[32:47]
    ds_read_b128 v[56:59], v13 offset:0
    ds_read_b64_tr_b16 v[60:61], v20 offset:2048
    ds_read_b64_tr_b16 v[62:63], v20 offset:2560
    v_mfma_f32_32x32x16_bf16 v[32:47], v[92:95], v[88:91], v[32:47]
    ds_read_b128 v[64:67], v14 offset:0
    ds_read_b64_tr_b16 v[68:69], v20 offset:4096
    ds_read_b64_tr_b16 v[70:71], v20 offset:4608
    v_mfma_f32_32x32x16_bf16 v[32:47], v[100:103], v[96:99], v[32:47]
    ds_read_b128 v[72:75], v15 offset:0
    ds_read_b64_tr_b16 v[76:77], v20 offset:6144
    ds_read_b64_tr_b16 v[78:79], v20 offset:6656
    v_mfma_f32_32x32x16_bf16 v[32:47], v[108:111], v[104:107], v[32:47]
    s_waitcnt lgkmcnt(0)
    s_barrier
    ds_read_b128 v[80:83], v12 offset:16384
    ds_read_b64_tr_b16 v[84:85], v20 offset:16384
    ds_read_b64_tr_b16 v[86:87], v20 offset:16896
    v_mfma_f32_32x32x16_bf16 v[32:47], v[52:55], v[48:51], v[32:47]
    ds_read_b128 v[88:91], v13 offset:16384
    ds_read_b64_tr_b16 v[92:93], v20 offset:18432
    ds_read_b64_tr_b16 v[94:95], v20 offset:18944
    v_mfma_f32_32x32x16_bf16 v[32:47], v[60:63], v[56:59], v[32:47]
    ds_read_b128 v[96:99], v14 offset:16384
    ds_read_b64_tr_b16 v[100:101], v20 offset:20480
    ds_read_b64_tr_b16 v[102:103], v20 offset:20992
    v_mfma_f32_32x32x16_bf16 v[32:47], v[68:71], v[64:67], v[32:47]
    ds_read_b128 v[104:107], v15 offset:16384
    ds_read_b64_tr_b16 v[108:109], v20 offset:22528
    ds_read_b64_tr_b16 v[110:111], v20 offset:23040
    v_mfma_f32_32x32x16_bf16 v[32:47], v[76:79], v[72:75], v[32:47]
    s_waitcnt lgkmcnt(0)
    s_barrier
    ds_read_b128 v[48:51], v12 offset:32768
    ds_read_b64_tr_b16 v[52:53], v20 offset:32768
    ds_read_b64_tr_b16 v[54:55], v20 offset:33280
    v_mfma_f32_32x32x16_bf16 v[32:47], v[84:87], v[80:83], v[32:47]
    ds_read_b128 v[56:59], v13 offset:32768
    ds_read_b64_tr_b16 v[60:61], v20 offset:34816
    ds_read_b64_tr_b16 v[62:63], v20 offset:35328
    v_mfma_f32_32x32x16_bf16 v[32:47], v[92:95], v[88:91], v[32:47]
    ds_read_b128 v[64:67], v14 offset:32768
    ds_read_b64_tr_b16 v[68:69], v20 offset:36864
    ds_read_b64_tr_b16 v[70:71], v20 offset:37376
    v_mfma_f32_32x32x16_bf16 v[32:47], v[100:103], v[96:99], v[32:47]
    ds_read_b128 v[72:75], v15 offset:32768
    ds_read_b64_tr_b16 v[76:77], v20 offset:38912
    ds_read_b64_tr_b16 v[78:79], v20 offset:39424
    v_mfma_f32_32x32x16_bf16 v[32:47], v[108:111], v[104:107], v[32:47]
    s_waitcnt lgkmcnt(0)
    s_barrier
    ds_read_b128 v[80:83], v16 offset:0
    ds_read_b64_tr_b16 v[84:85], v21 offset:0
    ds_read_b64_tr_b16 v[86:87], v21 offset:512
    v_mfma_f32_32x32x16_bf16 v[32:47], v[52:55], v[48:51], v[32:47]
    ds_read_b128 v[88:91], v17 offset:0
    ds_read_b64_tr_b16 v[92:93], v21 offset:2048
    ds_read_b64_tr_b16 v[94:95], v21 offset:2560
    v_mfma_f32_32x32x16_bf16 v[32:47], v[60:63], v[56:59], v[32:47]
    ds_read_b128 v[96:99], v18 offset:0
    ds_read_b64_tr_b16 v[100:101], v21 offset:4096
    ds_read_b64_tr_b16 v[102:103], v21 offset:4608
    v_mfma_f32_32x32x16_bf16 v[32:47], v[68:71], v[64:67], v[32:47]
    ds_read_b128 v[104:107], v19 offset:0
    ds_read_b64_tr_b16 v[108:109], v21 offset:6144
    ds_read_b64_tr_b16 v[110:111], v21 offset:6656
    v_mfma_f32_32x32x16_bf16 v[32:47], v[76:79], v[72:75], v[32:47]
    s_waitcnt lgkmcnt(0)
    s_barrier
    ds_read_b128 v[48:51], v16 offset:16384
    ds_read_b64_tr_b16 v[52:53], v21 offset:16384
    ds_read_b64_tr_b16 v[54:55], v21 offset:16896
    v_mfma_f32_32x32x16_bf16 v[32:47], v[84:87], v[80:83], v[32:47]
    ds_read_b128 v[56:59], v17 offset:16384
    ds_read_b64_tr_b16 v[60:61], v21 offset:18432
    ds_read_b64_tr_b16 v[62:63], v21 offset:18944
    v_mfma_f32_32x32x16_bf16 v[32:47], v[92:95], v[88:91], v[32:47]
    ds_read_b128 v[64:67], v18 offset:16384
    ds_read_b64_tr_b16 v[68:69], v21 offset:20480
    ds_read_b64_tr_b16 v[70:71], v21 offset:20992
    v_mfma_f32_32x32x16_bf16 v[32:47], v[100:103], v[96:99], v[32:47]
    ds_read_b128 v[72:75], v19 offset:16384
    ds_read_b64_tr_b16 v[76:77], v21 offset:22528
    ds_read_b64_tr_b16 v[78:79], v21 offset:23040
    v_mfma_f32_32x32x16_bf16 v[32:47], v[108:111], v[104:107], v[32:47]
    s_waitcnt lgkmcnt(0)
    s_barrier
    ds_read_b128 v[80:83], v16 offset:32768
    ds_read_b64_tr_b16 v[84:85], v21 offset:32768
    ds_read_b64_tr_b16 v[86:87], v21 offset:33280
    v_mfma_f32_32x32x16_bf16 v[32:47], v[52:55], v[48:51], v[32:47]
    ds_read_b128 v[88:91], v17 offset:32768
    ds_read_b64_tr_b16 v[92:93], v21 offset:34816
    ds_read_b64_tr_b16 v[94:95], v21 offset:35328
    v_mfma_f32_32x32x16_bf16 v[32:47], v[60:63], v[56:59], v[32:47]
    ds_read_b128 v[96:99], v18 offset:32768
    ds_read_b64_tr_b16 v[100:101], v21 offset:36864
    ds_read_b64_tr_b16 v[102:103], v21 offset:37376
    v_mfma_f32_32x32x16_bf16 v[32:47], v[68:71], v[64:67], v[32:47]
    ds_read_b128 v[104:107], v19 offset:32768
    ds_read_b64_tr_b16 v[108:109], v21 offset:38912
    ds_read_b64_tr_b16 v[110:111], v21 offset:39424
    v_mfma_f32_32x32x16_bf16 v[32:47], v[76:79], v[72:75], v[32:47]
    s_waitcnt lgkmcnt(0)
    s_barrier
    ds_read_b128 v[48:51], v12 offset:0
    ds_read_b64_tr_b16 v[52:53], v20 offset:0
    ds_read_b64_tr_b16 v[54:55], v20 offset:512
    v_mfma_f32_32x32x16_bf16 v[32:47], v[84:87], v[80:83], v[32:47]
    ds_read_b128 v[56:59], v13 offset:0
    ds_read_b64_tr_b16 v[60:61], v20 offset:2048
    ds_read_b64_tr_b16 v[62:63], v20 offset:2560
    v_mfma_f32_32x32x16_bf16 v[32:47], v[92:95], v[88:91], v[32:47]
    ds_read_b128 v[64:67], v14 offset:0
    ds_read_b64_tr_b16 v[68:69], v20 offset:4096
    ds_read_b64_tr_b16 v[70:71], v20 offset:4608
    v_mfma_f32_32x32x16_bf16 v[32:47], v[100:103], v[96:99], v[32:47]
    ds_read_b128 v[72:75], v15 offset:0
    ds_read_b64_tr_b16 v[76:77], v20 offset:6144
    ds_read_b64_tr_b16 v[78:79], v20 offset:6656
    v_mfma_f32_32x32x16_bf16 v[32:47], v[108:111], v[104:107], v[32:47]
    s_waitcnt lgkmcnt(0)
    s_barrier
    ds_read_b128 v[80:83], v12 offset:16384
    ds_read_b64_tr_b16 v[84:85], v20 offset:16384
    ds_read_b64_tr_b16 v[86:87], v20 offset:16896
    v_mfma_f32_32x32x16_bf16 v[32:47], v[52:55], v[48:51], v[32:47]
    ds_read_b128 v[88:91], v13 offset:16384
    ds_read_b64_tr_b16 v[92:93], v20 offset:18432
    ds_read_b64_tr_b16 v[94:95], v20 offset:18944
    v_mfma_f32_32x32x16_bf16 v[32:47], v[60:63], v[56:59], v[32:47]
    ds_read_b128 v[96:99], v14 offset:16384
    ds_read_b64_tr_b16 v[100:101], v20 offset:20480
    ds_read_b64_tr_b16 v[102:103], v20 offset:20992
    v_mfma_f32_32x32x16_bf16 v[32:47], v[68:71], v[64:67], v[32:47]
    ds_read_b128 v[104:107], v15 offset:16384
    ds_read_b64_tr_b16 v[108:109], v20 offset:22528
    ds_read_b64_tr_b16 v[110:111], v20 offset:23040
    v_mfma_f32_32x32x16_bf16 v[32:47], v[76:79], v[72:75], v[32:47]
    s_waitcnt lgkmcnt(0)
    s_barrier
    ds_read_b128 v[48:51], v12 offset:32768
    ds_read_b64_tr_b16 v[52:53], v20 offset:32768
    ds_read_b64_tr_b16 v[54:55], v20 offset:33280
    v_mfma_f32_32x32x16_bf16 v[32:47], v[84:87], v[80:83], v[32:47]
    ds_read_b128 v[56:59], v13 offset:32768
    ds_read_b64_tr_b16 v[60:61], v20 offset:34816
    ds_read_b64_tr_b16 v[62:63], v20 offset:35328
    v_mfma_f32_32x32x16_bf16 v[32:47], v[92:95], v[88:91], v[32:47]
    ds_read_b128 v[64:67], v14 offset:32768
    ds_read_b64_tr_b16 v[68:69], v20 offset:36864
    ds_read_b64_tr_b16 v[70:71], v20 offset:37376
    v_mfma_f32_32x32x16_bf16 v[32:47], v[100:103], v[96:99], v[32:47]
    ds_read_b128 v[72:75], v15 offset:32768
    ds_read_b64_tr_b16 v[76:77], v20 offset:38912
    ds_read_b64_tr_b16 v[78:79], v20 offset:39424
    v_mfma_f32_32x32x16_bf16 v[32:47], v[108:111], v[104:107], v[32:47]
    s_waitcnt lgkmcnt(0)
    s_barrier
    ds_read_b128 v[80:83], v16 offset:0
    ds_read_b64_tr_b16 v[84:85], v21 offset:0
    ds_read_b64_tr_b16 v[86:87], v21 offset:512
    v_mfma_f32_32x32x16_bf16 v[32:47], v[52:55], v[48:51], v[32:47]
    ds_read_b128 v[88:91], v17 offset:0
    ds_read_b64_tr_b16 v[92:93], v21 offset:2048
    ds_read_b64_tr_b16 v[94:95], v21 offset:2560
    v_mfma_f32_32x32x16_bf16 v[32:47], v[60:63], v[56:59], v[32:47]
    ds_read_b128 v[96:99], v18 offset:0
    ds_read_b64_tr_b16 v[100:101], v21 offset:4096
    ds_read_b64_tr_b16 v[102:103], v21 offset:4608
    v_mfma_f32_32x32x16_bf16 v[32:47], v[68:71], v[64:67], v[32:47]
    ds_read_b128 v[104:107], v19 offset:0
    ds_read_b64_tr_b16 v[108:109], v21 offset:6144
    ds_read_b64_tr_b16 v[110:111], v21 offset:6656
    v_mfma_f32_32x32x16_bf16 v[32:47], v[76:79], v[72:75], v[32:47]
    ds_read_b64 v[112:113], v24
    ds_read_b64 v[114:115], v25
    ds_read_b64 v[116:117], v26
    ds_read_b64 v[118:119], v27
    s_waitcnt lgkmcnt(4)
    v_mfma_f32_32x32x16_bf16 v[32:47], v[84:87], v[80:83], v[32:47]
    ds_read_u16 v48, v28 offset:0
    ds_read_u16 v49, v28 offset:128
    ds_read_u16 v50, v28 offset:256
    ds_read_u16 v51, v28 offset:384
    ds_read_u16 v52, v28 offset:1024
    ds_read_u16 v53, v28 offset:1152
    ds_read_u16 v54, v28 offset:1280
    ds_read_u16 v55, v28 offset:1408
    ds_read_u16 v56, v28 offset:2048
    ds_read_u16 v57, v28 offset:2176
    ds_read_u16 v58, v28 offset:2304
    ds_read_u16 v59, v28 offset:2432
    ds_read_u16 v60, v28 offset:3072
    ds_read_u16 v61, v28 offset:3200
    ds_read_u16 v62, v28 offset:3328
    ds_read_u16 v63, v28 offset:3456
    v_mfma_f32_32x32x16_bf16 v[32:47], v[92:95], v[88:91], v[32:47]
    v_mfma_f32_32x32x16_bf16 v[32:47], v[100:103], v[96:99], v[32:47]
    v_mfma_f32_32x32x16_bf16 v[32:47], v[108:111], v[104:107], v[32:47]
    s_waitcnt lgkmcnt(12)
    v_lshlrev_b32 v66, 16, v112
    v_and_b32 v67, 0xffff0000, v112
    v_lshlrev_b32 v68, 16, v113
    v_and_b32 v69, 0xffff0000, v113
    v_lshlrev_b32 v48, 16, v48
    v_lshlrev_b32 v49, 16, v49
    v_lshlrev_b32 v50, 16, v50
    v_lshlrev_b32 v51, 16, v51
    v_add_f32 v66, v66, v48
    v_add_f32 v67, v67, v49
    v_add_f32 v68, v68, v50
    v_add_f32 v69, v69, v51
    v_cvt_pk_bf16_f32 v120, v66, v67
    v_cvt_pk_bf16_f32 v121, v68, v69
    s_waitcnt lgkmcnt(8)
    v_lshlrev_b32 v66, 16, v114
    v_and_b32 v67, 0xffff0000, v114
    v_lshlrev_b32 v68, 16, v115
    v_and_b32 v69, 0xffff0000, v115
    v_lshlrev_b32 v52, 16, v52
    v_lshlrev_b32 v53, 16, v53
    v_lshlrev_b32 v54, 16, v54
    v_lshlrev_b32 v55, 16, v55
    v_add_f32 v66, v66, v52
    v_add_f32 v67, v67, v53
    v_add_f32 v68, v68, v54
    v_add_f32 v69, v69, v55
    v_cvt_pk_bf16_f32 v122, v66, v67
    v_cvt_pk_bf16_f32 v123, v68, v69
    s_waitcnt lgkmcnt(4)
    v_lshlrev_b32 v66, 16, v116
    v_and_b32 v67, 0xffff0000, v116
    v_lshlrev_b32 v68, 16, v117
    v_and_b32 v69, 0xffff0000, v117
    v_lshlrev_b32 v56, 16, v56
    v_lshlrev_b32 v57, 16, v57
    v_lshlrev_b32 v58, 16, v58
    v_lshlrev_b32 v59, 16, v59
    v_add_f32 v66, v66, v56
    v_add_f32 v67, v67, v57
    v_add_f32 v68, v68, v58
    v_add_f32 v69, v69, v59
    v_cvt_pk_bf16_f32 v124, v66, v67
    v_cvt_pk_bf16_f32 v125, v68, v69
    s_waitcnt lgkmcnt(0)
    v_lshlrev_b32 v66, 16, v118
    v_and_b32 v67, 0xffff0000, v118
    v_lshlrev_b32 v68, 16, v119
    v_and_b32 v69, 0xffff0000, v119
    v_lshlrev_b32 v60, 16, v60
    v_lshlrev_b32 v61, 16, v61
    v_lshlrev_b32 v62, 16, v62
    v_lshlrev_b32 v63, 16, v63
    v_add_f32 v66, v66, v60
    v_add_f32 v67, v67, v61
    v_add_f32 v68, v68, v62
    v_add_f32 v69, v69, v63
    v_cvt_pk_bf16_f32 v126, v66, v67
    v_cvt_pk_bf16_f32 v127, v68, v69
    v_cvt_pk_bf16_f32 v64, v32, v33
    v_cvt_pk_bf16_f32 v65, v34, v35
    v_lshlrev_b32 v66, 16, v120
    v_and_b32 v67, 0xffff0000, v120
    v_lshlrev_b32 v68, 16, v121
    v_and_b32 v69, 0xffff0000, v121
    v_lshlrev_b32 v72, 16, v64
    v_and_b32 v73, 0xffff0000, v64
    v_lshlrev_b32 v74, 16, v65
    v_and_b32 v75, 0xffff0000, v65
    v_add_f32 v66, v66, v72
    v_add_f32 v67, v67, v73
    v_add_f32 v68, v68, v74
    v_add_f32 v69, v69, v75
    v_cvt_pk_bf16_f32 v112, v66, v67
    v_cvt_pk_bf16_f32 v113, v68, v69
    ds_write_b64 v24, v[112:113]
    v_cvt_pk_bf16_f32 v64, v36, v37
    v_cvt_pk_bf16_f32 v65, v38, v39
    v_lshlrev_b32 v66, 16, v122
    v_and_b32 v67, 0xffff0000, v122
    v_lshlrev_b32 v68, 16, v123
    v_and_b32 v69, 0xffff0000, v123
    v_lshlrev_b32 v72, 16, v64
    v_and_b32 v73, 0xffff0000, v64
    v_lshlrev_b32 v74, 16, v65
    v_and_b32 v75, 0xffff0000, v65
    v_add_f32 v66, v66, v72
    v_add_f32 v67, v67, v73
    v_add_f32 v68, v68, v74
    v_add_f32 v69, v69, v75
    v_cvt_pk_bf16_f32 v114, v66, v67
    v_cvt_pk_bf16_f32 v115, v68, v69
    ds_write_b64 v25, v[114:115]
    v_cvt_pk_bf16_f32 v64, v40, v41
    v_cvt_pk_bf16_f32 v65, v42, v43
    v_lshlrev_b32 v66, 16, v124
    v_and_b32 v67, 0xffff0000, v124
    v_lshlrev_b32 v68, 16, v125
    v_and_b32 v69, 0xffff0000, v125
    v_lshlrev_b32 v72, 16, v64
    v_and_b32 v73, 0xffff0000, v64
    v_lshlrev_b32 v74, 16, v65
    v_and_b32 v75, 0xffff0000, v65
    v_add_f32 v66, v66, v72
    v_add_f32 v67, v67, v73
    v_add_f32 v68, v68, v74
    v_add_f32 v69, v69, v75
    v_cvt_pk_bf16_f32 v116, v66, v67
    v_cvt_pk_bf16_f32 v117, v68, v69
    ds_write_b64 v26, v[116:117]
    v_cvt_pk_bf16_f32 v64, v44, v45
    v_cvt_pk_bf16_f32 v65, v46, v47
    v_lshlrev_b32 v66, 16, v126
    v_and_b32 v67, 0xffff0000, v126
    v_lshlrev_b32 v68, 16, v127
    v_and_b32 v69, 0xffff0000, v127
    v_lshlrev_b32 v72, 16, v64
    v_and_b32 v73, 0xffff0000, v64
    v_lshlrev_b32 v74, 16, v65
    v_and_b32 v75, 0xffff0000, v65
    v_add_f32 v66, v66, v72
    v_add_f32 v67, v67, v73
    v_add_f32 v68, v68, v74
    v_add_f32 v69, v69, v75
    v_cvt_pk_bf16_f32 v118, v66, v67
    v_cvt_pk_bf16_f32 v119, v68, v69
    ds_write_b64 v27, v[118:119]
    s_waitcnt lgkmcnt(0)
    s_barrier
    ds_read_b128 v[32:35], v29
    ds_read_b128 v[36:39], v29 offset:1024
    v_add_u32 v23, 8192, v22
    s_waitcnt lgkmcnt(1)
    global_store_dwordx4 v22, v[32:35], s[30:31]
    s_waitcnt lgkmcnt(0)
    global_store_dwordx4 v23, v[36:39], s[30:31]
    s_endpgm
L_k3_exit:
    s_endpgm
.section .rodata,"a"
.p2align 6
.amdhsa_kernel prep_kernel
  .amdhsa_next_free_vgpr 128
  .amdhsa_next_free_sgpr 40
  .amdhsa_accum_offset 128
  .amdhsa_group_segment_fixed_size 0
  .amdhsa_kernarg_size 120
  .amdhsa_user_sgpr_count 2
  .amdhsa_user_sgpr_kernarg_segment_ptr 1
  .amdhsa_system_sgpr_workgroup_id_x 1
.end_amdhsa_kernel
.p2align 6
.amdhsa_kernel mid_kernel
  .amdhsa_next_free_vgpr 128
  .amdhsa_next_free_sgpr 40
  .amdhsa_accum_offset 128
  .amdhsa_group_segment_fixed_size 0
  .amdhsa_kernarg_size 120
  .amdhsa_user_sgpr_count 2
  .amdhsa_user_sgpr_kernarg_segment_ptr 1
  .amdhsa_system_sgpr_workgroup_id_x 1
.end_amdhsa_kernel
.p2align 6
.amdhsa_kernel fin_kernel
  .amdhsa_next_free_vgpr 128
  .amdhsa_next_free_sgpr 40
  .amdhsa_accum_offset 128
  .amdhsa_group_segment_fixed_size 0
  .amdhsa_kernarg_size 120
  .amdhsa_user_sgpr_count 2
  .amdhsa_user_sgpr_kernarg_segment_ptr 1
  .amdhsa_system_sgpr_workgroup_id_x 1
.end_amdhsa_kernel
```
